```python
import torch

def _softmax(x, axis=-1):
    return torch.softmax(x, dim=axis)

def _gelu(x):
    return torch.nn.functional.gelu(x, approximate='tanh')

def _silu(x):
    return torch.nn.functional.silu(x)

def _sigmoid(x):
    return torch.sigmoid(x)

def _layernorm(x, axis=-1, eps=1e-05):
    m = x.mean(dim=axis, keepdim=True)
    v = x.var(dim=axis, keepdim=True, unbiased=False)
    return (x - m) / torch.sqrt(v + eps)

def _scatter_add(tgt, idx, src, axis=0):
    return tgt.clone().index_add_(axis, idx, src)

def _segment_sum(src, seg, n):
    out = torch.zeros((n,) + src.shape[1:], dtype=src.dtype)
    return out.index_add_(0, seg, src)

def _pad(x, pw):
    flat = tuple((v for pair in reversed(pw) for v in pair))
    return torch.nn.functional.pad(x, flat)
kernel_name = 'adaLN_cond__sliding_block_cached__geglu_ffn__decode'

def setup_inputs():

    _w = lambda a: (lambda t: t.to(torch.bfloat16) if t.is_floating_point() else t)(torch.as_tensor(a))

    def _A_setup():
        B, Sq, D = (1, 1, 640)
        Hq, Hkv, Sk, Dh = (32, 32, 16384, 128)
        assert Hq % Hkv == 0, (Hq, Hkv)
        return {'x': _w((lambda *s: torch.randn(*s, dtype=torch.bfloat16) * 0.1)(B, Sq, D)), 'k_cache': _w((lambda *s: torch.randn(*s, dtype=torch.bfloat16) * 0.8)(B, Hkv, Sk, Dh)), 'v_cache': _w((lambda *s: torch.randn(*s, dtype=torch.bfloat16) * 0.8)(B, Hkv, Sk, Dh)), 'wq': _w((lambda *s: torch.randn(*s, dtype=torch.bfloat16) * 0.8)(D, Hq * Dh) * D ** (-0.5)), 'wo': _w((lambda *s: torch.randn(*s, dtype=torch.bfloat16) * 0.8)(Hq * Dh, D) * (Hq * Dh) ** (-0.5))}
    _A_in = _A_setup()

    def _B_setup():
        B, S, D, F = (1, 1, 640, 1728)
        return {'x': _w((lambda *s: torch.randn(*s, dtype=torch.bfloat16) * 0.1)(B, S, D)), 'w_gate': _w((lambda *s: torch.randn(*s, dtype=torch.bfloat16) * 0.1)(D, F)), 'w_up': _w((lambda *s: torch.randn(*s, dtype=torch.bfloat16) * 0.1)(D, F)), 'w_down': _w((lambda *s: torch.randn(*s, dtype=torch.bfloat16) * 0.1)(F, D))}
    _B_in = _B_setup()
    return {'A_x': _A_in['x'], 'A_k_cache': _A_in['k_cache'], 'A_v_cache': _A_in['v_cache'], 'A_wq': _A_in['wq'], 'A_wo': _A_in['wo'], 'B_x': _B_in['x'], 'B_w_gate': _B_in['w_gate'], 'B_w_up': _B_in['w_up'], 'B_w_down': _B_in['w_down'], 'c': _w((lambda *s: torch.randn(*s, dtype=torch.bfloat16) * 0.8)(1, 640) * 8.0), 'w_mod': _w((lambda *s: torch.randn(*s, dtype=torch.bfloat16) * 0.8)(640, 6 * 640) * 640 ** (-0.5) * 8.0)}

def reference(A_x, A_k_cache, A_v_cache, A_wq, A_wo, B_x, B_w_gate, B_w_up, B_w_down, c, w_mod):

    def _A_ref(x, k_cache, v_cache, wq, wo):
        B, Sq, D = x.shape
        Hq, Dh = (32, 128)
        Hkv, Sk = (k_cache.shape[1], k_cache.shape[2])
        W = min(4096, max(256, Sk // 4))
        rep = Hq // Hkv
        q = (lambda x, *d: x.permute(*d))((x @ wq).reshape(B, Sq, Hq, Dh), 0, 2, 1, 3)
        k = (lambda x, n, axis: torch.repeat_interleave(x, n, dim=axis))(k_cache[:, :, Sk - W:, :], rep, axis=1)
        v = (lambda x, n, axis: torch.repeat_interleave(x, n, dim=axis))(v_cache[:, :, Sk - W:, :], rep, axis=1)
        scores = torch.einsum('bhqd,bhkd->bhqk', q, k) * Dh ** (-0.5)
        p = _softmax(scores, axis=-1)
        o = torch.einsum('bhqk,bhkd->bhqd', p, v)
        return (lambda x, *d: x.permute(*d))(o, 0, 2, 1, 3).reshape(B, Sq, Hq * Dh) @ wo

    def _B_ref(x, w_gate, w_up, w_down):
        return _gelu(x @ w_gate) * (x @ w_up) @ w_down
    x = A_x
    mod = (_silu(c) @ w_mod).reshape(c.shape[0], 6, 1, -1)
    sa, ca, ga, sb, cb, gb = (mod[:, 0].clone(), mod[:, 1].clone(), mod[:, 2].clone(), mod[:, 3].clone(), mod[:, 4].clone(), mod[:, 5].clone())
    h = _layernorm(x, axis=-1) * (1 + ca) + sa
    x = x + ga * _A_ref(h, A_k_cache, A_v_cache, A_wq, A_wo)
    h = _layernorm(x, axis=-1) * (1 + cb) + sb
    x = x + gb * _B_ref(h, B_w_gate, B_w_up, B_w_down)
    return x
```

```asm
; @launch grid=(256,1,1) block=(1024,1,1) lds=28672
.amdgcn_target "amdgcn-amd-amdhsa--gfx950"
.text
.globl adaLN_cond__sliding_block_cached__geglu_ffn__decode_kernel
.p2align 8
.type adaLN_cond__sliding_block_cached__geglu_ffn__decode_kernel,@function
adaLN_cond__sliding_block_cached__geglu_ffn__decode_kernel:
    s_cmp_lt_u32 s2, 64
    s_cbranch_scc1 L_front
    s_load_dwordx2 s[40:41], s[0:1], 8
    s_load_dwordx2 s[36:37], s[0:1], 104
    v_lshrrev_b32 v2, 6, v0
    s_lshr_b32 s101, s2, 5
    s_and_b32 s100, s2, 31
    v_add_u32 v4, s100, v2
    v_mul_u32_u24 v5, 94, v4
    s_mul_i32 s72, s101, 174764
    s_lshl_b32 s74, s100, 22
    v_mul_u32_u24 v3, 12288, v2
    s_add_u32 s72, s72, s74
    v_lshrrev_b32 v5, 10, v5
    v_mad_i32_i24 v4, v5, -11, v4
    s_add_u32 s74, s72, 2965840
    s_and_b32 s74, s74, 0xfffffc00
    s_add_u32 s42, s72, 2971644
    v_lshl_add_u32 v20, v0, 4, s74
    s_and_b32 s42, s42, 0xfffffc00
    v_sub_u32 v20, v20, v3
    s_mov_b32 s43, 0x20000
    v_lshl_add_u32 v5, v4, 10, v20
    s_cmp_ge_u32 s2, 256
    s_cbranch_scc1 L_quit
    s_waitcnt lgkmcnt(0)
    buffer_load_dwordx4 v[32:35], v5, s[40:43], 0 offen nt
    v_readfirstlane_b32 s60, v4
    s_lshl_b32 s60, s60, 10
    s_load_dword s31, s[36:37], 0
    v_readfirstlane_b32 s30, v2
    s_load_dwordx2 s[44:45], s[0:1], 16
    s_load_dwordx2 s[12:13], s[0:1], 32
    s_load_dwordx2 s[52:53], s[0:1], 96
    s_add_u32 s61, s60, 1024
    s_sub_u32 s71, s61, 11264
    s_min_u32 s61, s61, s71
    s_cmp_lt_u32 s30, 6
    s_cbranch_scc1 L_retA
    s_cmp_eq_u32 s30, 15
    s_cbranch_scc1 HA_23
    s_cmp_eq_u32 s30, 14
    s_cbranch_scc1 HA_25
    s_cmp_eq_u32 s30, 13
    s_cbranch_scc1 HA_30
    s_cmp_eq_u32 s30, 12
    s_cbranch_scc1 HA_32
    s_cmp_eq_u32 s30, 11
    s_cbranch_scc1 HA_33
    s_cmp_eq_u32 s30, 10
    s_cbranch_scc1 HA_38
    s_cmp_eq_u32 s30, 9
    s_cbranch_scc1 HA_41
    s_cmp_eq_u32 s30, 8
    s_cbranch_scc1 HA_47
    s_cmp_eq_u32 s30, 7
    s_cbranch_scc1 BA_62
    s_cmp_eq_u32 s30, 6
    s_cbranch_scc1 BA_63
L_retA:
    s_waitcnt vmcnt(0)
    buffer_load_dwordx4 v[36:39], v20, s[40:43], s61 offen nt
    s_branch L_att
L_quit:
    s_waitcnt lgkmcnt(0)
L_end:
    s_endpgm
L_front:
    s_load_dwordx2 s[40:41], s[0:1], 80
    s_load_dwordx2 s[48:49], s[0:1], 72
    s_load_dwordx2 s[52:53], s[0:1], 0
    s_load_dwordx2 s[44:45], s[0:1], 24
    s_load_dwordx2 s[36:37], s[0:1], 104
    v_lshrrev_b32 v34, 3, v0
    v_and_b32 v35, 7, v0
    s_mov_b32 s3, s2
    s_mov_b32 s50, 1280
    s_mov_b32 s51, 0x20000
    s_cmp_ge_u32 s3, 40
    s_cbranch_scc1 NX_2
    s_setprio 3
    s_bitcmp0_b32 s2, 2
    s_cselect_b32 s73, 3, 2
    s_cselect_b32 s67, 0, 384
    s_cselect_b32 s68, 15360, 0x40000000
    v_mad_u32_u24 v94, v34, s73, v35
    s_mul_i32 s72, s73, 7680
    s_mul_i32 s62, s67, 7680
    v_add_lshl_u32 v94, v94, s67, 1
    s_lshr_b32 s60, s2, 3
    s_and_b32 s65, s2, 3
    v_mul_u32_u24 v11, s72, v34
    s_lshl2_add_u32 s65, s60, s65
    s_lshl_b32 s63, s65, 7
    v_lshl_add_u32 v11, v35, 4, v11
    s_add_u32 s62, s62, s63
    s_add_u32 s63, s62, 7680
    s_add_u32 s68, s68, s62
    s_mov_b32 s42, 4915200
    s_mov_b32 s43, 0x20000
    s_waitcnt lgkmcnt(0)
    buffer_load_ushort v94, v94, s[48:51], 0 offen
    buffer_load_dwordx4 v[52:55], v11, s[40:43], s62 offen nt
    buffer_load_dwordx4 v[56:59], v11, s[40:43], s63 offen nt
    buffer_load_dwordx4 v[60:63], v11, s[40:43], s68 offen nt
    s_setprio 0
    s_sub_u32 s69, 3, s73
    s_mul_i32 s69, s69, 10240
    s_lshl_b32 s63, s65, 9
    s_add_u32 s69, s69, s63
    s_add_u32 s69, s69, 409600
NX_2:
    v_and_b32 v1, 63, v0
    s_lshr_b32 s60, s2, 3
    s_and_b32 s101, s2, 7
    v_mad_u32_u24 v10, v34, 5, v35
    s_xor_b32 s60, s60, 4
    s_lshl3_add_u32 s101, s101, s60
    v_lshlrev_b32 v90, 2, v1
    v_lshlrev_b32 v89, 4, v1
    s_lshl_b32 s70, s101, 7
    s_mov_b32 s54, 1280
    v_min_u32 v10, 639, v10
    s_mov_b32 s55, 0x20000
    s_mov_b32 s46, 5242880
    v_lshlrev_b32 v44, 1, v10
    s_mov_b32 s47, 0x20000
    v_mul_u32_u24 v95, 40960, v34
    v_lshl_add_u32 v95, v35, 4, v95
    s_waitcnt lgkmcnt(0)
    s_load_dword s31, s[36:37], 0
    s_cmp_lt_u32 s3, 40
    s_cbranch_scc1 NW_3
    buffer_load_dwordx4 v[84:87], v89, s[52:55], 0 offen
    buffer_load_dword v88, v90, s[52:55], 0 offen offset:1024
    buffer_load_ushort v44, v44, s[52:55], 0 offen
    buffer_load_dwordx4 v[64:67], v95, s[44:47], s70 offen nt
    s_add_u32 s61, s70, 8192
    buffer_load_dwordx4 v[68:71], v95, s[44:47], s61 offen nt
    s_add_u32 s61, s70, 16384
    buffer_load_dwordx4 v[72:75], v95, s[44:47], s61 offen nt
    s_add_u32 s61, s70, 24576
    buffer_load_dwordx4 v[76:79], v95, s[44:47], s61 offen nt
    s_add_u32 s61, s70, 32768
    buffer_load_dwordx4 v[80:83], v95, s[44:47], s61 offen nt
NW_3:
    s_load_dwordx16 s[4:19], s[0:1], 0
    s_load_dwordx8 s[20:27], s[0:1], 64
    s_load_dwordx2 s[28:29], s[0:1], 104
    v_lshrrev_b32 v2, 6, v0
    v_and_b32 v1, 63, v0
    v_readfirstlane_b32 s30, v2
    v_bfe_u32 v2, v0, 4, 2
    v_and_b32 v3, 15, v0
    s_mov_b32 s38, 917504
    s_mov_b32 s39, 0x20000
    s_and_b32 s61, s2, 7
    s_cmp_ge_u32 s61, 4
    s_cselect_b32 s60, 3, 0
    s_xor_b32 s60, s61, s60
    s_lshl_b32 s60, s60, 3
    s_lshr_b32 s2, s2, 3
    s_or_b32 s2, s2, s60
    s_lshr_b32 s60, s2, 3
    s_and_b32 s61, s2, 7
    s_lshl_b32 s62, s60, 2
    s_lshr_b32 s62, 0x56554444, s62
    s_and_b32 s62, s62, 15
    s_mov_b32 s64, 0xc080400
    s_mov_b32 s65, 0x201a1510
    s_lshl_b32 s63, s60, 3
    s_lshr_b64 s[64:65], s[64:65], s63
    s_and_b32 s64, s64, 255
    s_add_u32 s65, s64, s61
    s_sub_u32 s66, s2, s64
    s_sub_u32 s66, s66, s62
    s_add_u32 s66, s66, 37
    s_cmp_lt_u32 s61, s62
    s_cselect_b32 s2, s65, s66
    v_and_b32 v32, 1, v3
    v_lshlrev_b32 v32, 4, v32
    v_mov_b32 v33, 0xffff
    v_lshlrev_b32 v0, v32, v33
    v_bfe_u32 v33, v3, 1, 2
    v_cmp_eq_u32 vcc, 0, v33
    s_nop 1
    v_cndmask_b32 v4, 0, 1.0, vcc
    v_cmp_eq_u32 vcc, 1, v33
    s_nop 1
    v_cndmask_b32 v5, 0, 1.0, vcc
    v_cmp_eq_u32 vcc, 2, v33
    s_nop 1
    v_cndmask_b32 v6, 0, 1.0, vcc
    v_cmp_eq_u32 vcc, 3, v33
    s_nop 1
    v_cndmask_b32 v7, 0, 1.0, vcc
    v_and_b32 v33, 60, v1
    v_bfe_u32 v46, v33, 4, 1
    v_lshlrev_b32 v46, 6, v46
    v_bfe_u32 v32, v33, 5, 1
    v_lshl_add_u32 v46, v32, 4, v46
    v_bfe_u32 v32, v33, 3, 1
    v_lshl_add_u32 v46, v32, 5, v46
    v_and_b32 v32, 7, v33
    v_add_u32 v46, v46, v32
    v_lshlrev_b32 v46, 2, v46
    v_and_b32 v32, 3, v1
    v_mul_u32_u24 v32, 576, v32
    v_add_u32 v46, v46, v32
    s_mul_i32 s79, s30, 576
    v_lshlrev_b32 v45, 2, v1
    v_add_u32 v45, s79, v45
    v_and_b32 v47, 60, v1
    v_lshlrev_b32 v47, 2, v47
    v_lshlrev_b32 v10, 2, v10
    s_waitcnt lgkmcnt(0)
    s_add_u32 s31, s31, 1
    s_and_b32 s32, s31, 0xffff
    s_and_b32 s33, s31, 0x3ff
    v_mov_b32 v8, s32
    v_mov_b32 v9, s33
    s_mov_b32 s35, 0x3ff
    s_cmp_ge_u32 s3, 40
    s_cbranch_scc1 NC_1
    s_waitcnt vmcnt(3)
    v_lshlrev_b32 v12, 16, v94
    v_mul_f32 v32, 0xbfb8aa3b, v12
    v_exp_f32 v32, v32
    s_nop 0
    v_add_f32 v32, 1.0, v32
    v_min_f32 v32, 0x7f61b1e6, v32
    v_rcp_f32 v33, v32
    s_nop 0
    v_mul_f32 v34, v12, v33
    v_fma_f32 v35, -v34, v32, v12
    v_fma_f32 v12, v35, v33, v34
    v_cvt_pk_bf16_f32 v12, v12, v12
    s_nop 1
    v_and_b32_dpp v48, v12, v0 row_newbcast:0 row_mask:0xf bank_mask:0x3
    s_nop 1
    v_and_b32_dpp v48, v12, v0 row_newbcast:8 row_mask:0xf bank_mask:0xc
    v_pk_mul_f32 v[14:15], v[48:49], v[4:5] op_sel:[0,0] op_sel_hi:[0,1]
    v_pk_mul_f32 v[16:17], v[48:49], v[6:7] op_sel:[0,0] op_sel_hi:[0,1]
    v_and_b32_dpp v50, v12, v0 row_newbcast:1 row_mask:0xf bank_mask:0x3
    s_nop 1
    v_and_b32_dpp v50, v12, v0 row_newbcast:9 row_mask:0xf bank_mask:0xc
    v_pk_mul_f32 v[18:19], v[50:51], v[4:5] op_sel:[0,0] op_sel_hi:[0,1]
    v_pk_mul_f32 v[20:21], v[50:51], v[6:7] op_sel:[0,0] op_sel_hi:[0,1]
    s_waitcnt vmcnt(2)
    v_mfma_f32_16x16x32_bf16 v[22:25], v[52:55], v[14:17], 0
    v_and_b32_dpp v48, v12, v0 row_newbcast:2 row_mask:0xf bank_mask:0x3
    s_nop 1
    v_and_b32_dpp v48, v12, v0 row_newbcast:10 row_mask:0xf bank_mask:0xc
    v_pk_mul_f32 v[14:15], v[48:49], v[4:5] op_sel:[0,0] op_sel_hi:[0,1]
    v_pk_mul_f32 v[16:17], v[48:49], v[6:7] op_sel:[0,0] op_sel_hi:[0,1]
    s_waitcnt vmcnt(1)
    v_mfma_f32_16x16x32_bf16 v[22:25], v[56:59], v[18:21], v[22:25]
    s_waitcnt vmcnt(0)
    buffer_load_dwordx4 v[84:87], v89, s[52:55], 0 offen
    buffer_load_dword v88, v90, s[52:55], 0 offen offset:1024
    buffer_load_ushort v44, v44, s[52:55], 0 offen
    buffer_load_dwordx4 v[64:67], v95, s[44:47], s70 offen nt
    s_add_u32 s61, s70, 8192
    buffer_load_dwordx4 v[68:71], v95, s[44:47], s61 offen nt
    v_mfma_f32_16x16x32_bf16 v[22:25], v[60:63], v[14:17], v[22:25]
    s_nop 7
    v_permlane32_swap_b32 v22, v23
    v_permlane32_swap_b32 v24, v25
    s_nop 0
    v_add_f32_dpp v30, v23, v22 row_ror:8 row_mask:0xf bank_mask:0x3
    v_add_f32_dpp v31, v25, v24 row_ror:8 row_mask:0xf bank_mask:0x3
    ds_write_b32 v45, v30 offset:10240
    ds_write_b32 v45, v31 offset:10496
    s_waitcnt lgkmcnt(0)
    s_barrier
    s_cmp_lg_u32 s30, 0
    s_cbranch_scc1 NC_1
    v_and_b32 v32, 1, v1
    v_lshlrev_b32 v32, 4, v32
    v_lshl_add_u32 v32, v47, 1, v32
    ds_read_b128 v[14:17], v46 offset:10240
    ds_read_b128 v[18:21], v46 offset:12544
    ds_read_b128 v[22:25], v46 offset:14848
    ds_read_b128 v[26:29], v46 offset:17152
    s_waitcnt lgkmcnt(2)
    v_add_f32 v14, v14, v18
    v_add_f32 v15, v15, v19
    v_add_f32 v16, v16, v20
    v_add_f32 v17, v17, v21
    s_waitcnt lgkmcnt(0)
    v_add_f32 v22, v22, v26
    v_add_f32 v23, v23, v27
    v_add_f32 v24, v24, v28
    v_add_f32 v25, v25, v29
    v_add_f32 v14, v14, v22
    v_add_f32 v15, v15, v23
    v_add_f32 v16, v16, v24
    v_add_f32 v17, v17, v25
    v_add_f32_dpp v14, v14, v14 quad_perm:[1,0,3,2] row_mask:0xf bank_mask:0xf
    v_add_f32_dpp v15, v15, v15 quad_perm:[1,0,3,2] row_mask:0xf bank_mask:0xf
    v_add_f32_dpp v16, v16, v16 quad_perm:[1,0,3,2] row_mask:0xf bank_mask:0xf
    v_add_f32_dpp v17, v17, v17 quad_perm:[1,0,3,2] row_mask:0xf bank_mask:0xf
    v_add_f32_dpp v14, v14, v14 quad_perm:[2,3,0,1] row_mask:0xf bank_mask:0xf
    v_add_f32_dpp v15, v15, v15 quad_perm:[2,3,0,1] row_mask:0xf bank_mask:0xf
    v_add_f32_dpp v16, v16, v16 quad_perm:[2,3,0,1] row_mask:0xf bank_mask:0xf
    v_add_f32_dpp v17, v17, v17 quad_perm:[2,3,0,1] row_mask:0xf bank_mask:0xf
    s_mov_b32 vcc_lo, 0xaaaaaaaa
    s_mov_b32 vcc_hi, 0xaaaaaaaa
    v_cndmask_b32 v14, v14, v16, vcc
    v_cndmask_b32 v16, v15, v17, vcc
    v_mov_b32 v15, s31
    v_mov_b32 v17, s31
    s_mov_b32 exec_lo, 0x33333333
    s_mov_b32 exec_hi, 0x33333333
    buffer_store_dwordx4 v[14:17], v32, s[36:39], s69 offen sc1
    s_mov_b64 exec, -1
NC_1:
    s_cmp_ge_u32 s3, 40
    s_cbranch_scc1 XW_4
    s_waitcnt vmcnt(2)
XW_4:
    s_waitcnt vmcnt(5)
    v_and_b32 v89, 0xffff0000, v84
    v_lshlrev_b32 v84, 16, v84
    v_and_b32 v90, 0xffff0000, v85
    v_lshlrev_b32 v85, 16, v85
    v_and_b32 v91, 0xffff0000, v86
    v_lshlrev_b32 v86, 16, v86
    v_and_b32 v92, 0xffff0000, v87
    v_lshlrev_b32 v87, 16, v87
    v_and_b32 v93, 0xffff0000, v88
    v_lshlrev_b32 v88, 16, v88
    v_lshlrev_b32 v44, 16, v44
    v_add_f32 v32, v84, v85
    v_add_f32 v32, v32, v86
    v_add_f32 v32, v32, v87
    v_add_f32 v32, v32, v88
    v_add_f32 v32, v32, v89
    v_add_f32 v32, v32, v90
    v_add_f32 v32, v32, v91
    v_add_f32 v32, v32, v92
    v_add_f32 v32, v32, v93
    s_nop 1
    v_add_f32_dpp v32, v32, v32 quad_perm:[1,0,3,2] row_mask:0xf bank_mask:0xf
    s_nop 1
    v_add_f32_dpp v32, v32, v32 quad_perm:[2,3,0,1] row_mask:0xf bank_mask:0xf
    s_nop 1
    v_add_f32_dpp v32, v32, v32 row_half_mirror row_mask:0xf bank_mask:0xf
    s_nop 1
    v_add_f32_dpp v32, v32, v32 row_mirror row_mask:0xf bank_mask:0xf
    v_mov_b32 v35, v32
    s_nop 1
    v_permlane32_swap_b32 v35, v32
    v_add_f32 v32, v32, v35
    v_mov_b32 v35, v32
    s_nop 1
    v_permlane16_swap_b32 v35, v32
    v_add_f32 v32, v32, v35
    v_mul_f32 v32, 0x3acccccd, v32
    v_sub_f32 v35, v84, v32
    v_mul_f32 v33, v35, v35
    v_sub_f32 v35, v85, v32
    v_fmac_f32 v33, v35, v35
    v_sub_f32 v35, v86, v32
    v_fmac_f32 v33, v35, v35
    v_sub_f32 v35, v87, v32
    v_fmac_f32 v33, v35, v35
    v_sub_f32 v35, v88, v32
    v_fmac_f32 v33, v35, v35
    v_sub_f32 v35, v89, v32
    v_fmac_f32 v33, v35, v35
    v_sub_f32 v35, v90, v32
    v_fmac_f32 v33, v35, v35
    v_sub_f32 v35, v91, v32
    v_fmac_f32 v33, v35, v35
    v_sub_f32 v35, v92, v32
    v_fmac_f32 v33, v35, v35
    v_sub_f32 v35, v93, v32
    v_fmac_f32 v33, v35, v35
    s_nop 1
    v_add_f32_dpp v33, v33, v33 quad_perm:[1,0,3,2] row_mask:0xf bank_mask:0xf
    s_nop 1
    v_add_f32_dpp v33, v33, v33 quad_perm:[2,3,0,1] row_mask:0xf bank_mask:0xf
    s_nop 1
    v_add_f32_dpp v33, v33, v33 row_half_mirror row_mask:0xf bank_mask:0xf
    s_nop 1
    v_add_f32_dpp v33, v33, v33 row_mirror row_mask:0xf bank_mask:0xf
    v_mov_b32 v35, v33
    s_nop 1
    v_permlane32_swap_b32 v35, v33
    v_add_f32 v33, v33, v35
    v_mov_b32 v35, v33
    s_nop 1
    v_permlane16_swap_b32 v35, v33
    v_add_f32 v33, v33, v35
    v_mul_f32 v33, 0x3acccccd, v33
    v_cvt_pk_bf16_f32 v32, 0, v32
    v_cvt_pk_bf16_f32 v33, 0, v33
    v_add_f32 v33, 0x3727c5ac, v33
    v_cvt_pk_bf16_f32 v33, 0, v33
    v_readfirstlane_b32 s100, v32
    v_sqrt_f32 v33, v33
    s_nop 0
    v_cvt_pk_bf16_f32 v33, 0, v33
    v_rcp_f32 v34, v33
    v_sub_f32 v35, v44, v32
    v_cvt_pk_bf16_f32 v35, 0, v35
    v_mul_f32 v12, v35, v34
    v_fma_f32 v36, -v12, v33, v35
    v_fma_f32 v12, v36, v34, v12
    v_cvt_pk_bf16_f32 v12, 0, v12
    s_cmp_ge_u32 s3, 40
    s_cbranch_scc1 NR_5
    s_waitcnt vmcnt(1)
    s_add_u32 s61, s70, 16384
    buffer_load_dwordx4 v[72:75], v95, s[44:47], s61 offen nt
    s_waitcnt vmcnt(1)
    s_add_u32 s61, s70, 24576
    buffer_load_dwordx4 v[76:79], v95, s[44:47], s61 offen nt
    s_waitcnt vmcnt(1)
    s_add_u32 s61, s70, 32768
    buffer_load_dwordx4 v[80:83], v95, s[44:47], s61 offen nt
NR_5:
NV_6:
    s_cmp_lt_u32 s30, 7
    s_cbranch_scc1 L_retF
    s_cmp_eq_u32 s30, 15
    s_cbranch_scc1 HF_15
    s_cmp_eq_u32 s30, 14
    s_cbranch_scc1 HF_16
    s_cmp_eq_u32 s30, 13
    s_cbranch_scc1 HF_21
    s_cmp_eq_u32 s30, 12
    s_cbranch_scc1 HF_22
    s_cmp_eq_u32 s30, 11
    s_cbranch_scc1 HF_48
    s_cmp_eq_u32 s30, 10
    s_cbranch_scc1 HF_51
    s_cmp_eq_u32 s30, 9
    s_cbranch_scc1 HF_58
    s_cmp_eq_u32 s30, 8
    s_cbranch_scc1 HF_60
    s_cmp_eq_u32 s30, 7
    s_cbranch_scc1 HF_61
L_retF:
    s_mov_b32 s74, s3
    s_mov_b32 s70, 409600
    s_mov_b32 s71, 414720
    s_mov_b32 s72, 419840
    s_mov_b32 s73, 424960
    v_lshlrev_b32 v33, 1, v10
    v_mov_b32 v34, s31
    s_mov_b32 s3, s2
    s_sub_u32 s69, s3, 37
    v_and_b32 v35, 1, v2
    v_lshrrev_b32 v36, 1, v2
    v_lshl_add_u32 v36, v35, 3, v36
    v_mul_u32_u24 v11, 3456, v36
    v_and_b32 v35, 7, v3
    v_lshl_add_u32 v11, v35, 4, v11
    s_mul_i32 s62, s30, 221184
    s_lshl_b32 s63, s69, 7
    s_add_u32 s62, s62, s63
    s_add_u32 s62, s62, 114048
    v_add_u32 v11, s62, v11
    v_mov_b32 v56, s16
    v_mov_b32 v57, s17
    v_mov_b32 v35, s18
    v_mov_b32 v36, s19
    v_cmp_lt_u32 vcc, 7, v3
    s_nop 1
    v_cndmask_b32 v56, v56, v35, vcc
    v_cndmask_b32 v57, v57, v36, vcc
    v_add_co_u32 v56, vcc, v56, v11
    s_nop 1
    v_addc_co_u32 v57, vcc, 0, v57, vcc
    s_mov_b32 s64, 13824
    s_mov_b32 s65, 0
    s_mov_b32 s66, 41472
    s_mov_b32 s67, 0
    s_cmp_lt_u32 s74, 40
    s_cbranch_scc1 HB_9
    s_barrier
HB_9:
    s_mov_b32 s34, 0
PH_10:
    buffer_load_dwordx2 v[14:15], v33, s[36:39], s70 offen sc1
    buffer_load_dwordx2 v[16:17], v33, s[36:39], s71 offen sc1
    buffer_load_dwordx2 v[18:19], v33, s[36:39], s72 offen sc1
    buffer_load_dwordx2 v[20:21], v33, s[36:39], s73 offen sc1
    s_waitcnt vmcnt(0)
    v_xor_b32 v15, v15, v34
    v_xor_b32 v17, v17, v34
    v_xor_b32 v19, v19, v34
    v_xor_b32 v21, v21, v34
    v_or3_b32 v32, v15, v17, v19
    v_or_b32 v32, v32, v21
    v_cmp_ne_u32 vcc, 0, v32
    s_nop 0
    s_cbranch_vccz PHd_11
    s_add_u32 s34, s34, 1
    s_cmp_lt_u32 s34, 30000
    s_cbranch_scc1 PH_10
PHd_11:
    s_cmp_lt_u32 s3, 37
    s_cbranch_scc1 NE_12
    s_cmp_ge_u32 s30, 10
    s_cbranch_scc1 NE_12
    global_load_dwordx4 v[96:99], v[56:57], off offset:-3456 nt
    global_load_dwordx4 v[100:103], v[56:57], off offset:3456 nt
NE_12:
    v_add_f32 v14, v14, v18
    v_add_f32 v15, v16, v20
    v_cvt_pk_bf16_f32 v14, 0, v14
    v_cvt_pk_bf16_f32 v15, 0, v15
    v_add_f32 v15, 1.0, v15
    v_cvt_pk_bf16_f32 v15, 0, v15
    v_mul_f32 v12, v12, v15
    v_cvt_pk_bf16_f32 v12, 0, v12
    v_add_f32 v12, v12, v14
    v_cvt_pk_bf16_f32 v12, v12, v12
    s_nop 1
    v_and_b32_dpp v48, v12, v0 row_newbcast:0 row_mask:0xf bank_mask:0x3
    s_nop 1
    v_and_b32_dpp v48, v12, v0 row_newbcast:8 row_mask:0xf bank_mask:0xc
    v_pk_mul_f32 v[14:15], v[48:49], v[4:5] op_sel:[0,0] op_sel_hi:[0,1]
    v_pk_mul_f32 v[16:17], v[48:49], v[6:7] op_sel:[0,0] op_sel_hi:[0,1]
    v_and_b32_dpp v50, v12, v0 row_newbcast:1 row_mask:0xf bank_mask:0x3
    s_nop 1
    v_and_b32_dpp v50, v12, v0 row_newbcast:9 row_mask:0xf bank_mask:0xc
    v_pk_mul_f32 v[18:19], v[50:51], v[4:5] op_sel:[0,0] op_sel_hi:[0,1]
    v_pk_mul_f32 v[20:21], v[50:51], v[6:7] op_sel:[0,0] op_sel_hi:[0,1]
    v_mfma_f32_16x16x32_bf16 v[22:25], v[64:67], v[14:17], 0
    v_and_b32_dpp v48, v12, v0 row_newbcast:2 row_mask:0xf bank_mask:0x3
    s_nop 1
    v_and_b32_dpp v48, v12, v0 row_newbcast:10 row_mask:0xf bank_mask:0xc
    v_pk_mul_f32 v[14:15], v[48:49], v[4:5] op_sel:[0,0] op_sel_hi:[0,1]
    v_pk_mul_f32 v[16:17], v[48:49], v[6:7] op_sel:[0,0] op_sel_hi:[0,1]
    v_mfma_f32_16x16x32_bf16 v[22:25], v[68:71], v[18:21], v[22:25]
    v_and_b32_dpp v50, v12, v0 row_newbcast:3 row_mask:0xf bank_mask:0x3
    s_nop 1
    v_and_b32_dpp v50, v12, v0 row_newbcast:11 row_mask:0xf bank_mask:0xc
    v_pk_mul_f32 v[18:19], v[50:51], v[4:5] op_sel:[0,0] op_sel_hi:[0,1]
    v_pk_mul_f32 v[20:21], v[50:51], v[6:7] op_sel:[0,0] op_sel_hi:[0,1]
    v_mfma_f32_16x16x32_bf16 v[22:25], v[72:75], v[14:17], v[22:25]
    v_and_b32_dpp v48, v12, v0 row_newbcast:4 row_mask:0xf bank_mask:0x3
    s_nop 1
    v_and_b32_dpp v48, v12, v0 row_newbcast:12 row_mask:0xf bank_mask:0xc
    v_pk_mul_f32 v[14:15], v[48:49], v[4:5] op_sel:[0,0] op_sel_hi:[0,1]
    v_pk_mul_f32 v[16:17], v[48:49], v[6:7] op_sel:[0,0] op_sel_hi:[0,1]
    v_mfma_f32_16x16x32_bf16 v[22:25], v[76:79], v[18:21], v[22:25]
    s_nop 0
    v_mfma_f32_16x16x32_bf16 v[22:25], v[80:83], v[14:17], v[22:25]
    s_nop 7
    v_permlane32_swap_b32 v22, v23
    v_permlane32_swap_b32 v24, v25
    s_nop 0
    v_add_f32_dpp v30, v23, v22 row_ror:8 row_mask:0xf bank_mask:0x3
    v_add_f32_dpp v31, v25, v24 row_ror:8 row_mask:0xf bank_mask:0x3
    ds_write_b32 v45, v30 offset:1024
    ds_write_b32 v45, v31 offset:1280
    s_waitcnt lgkmcnt(0)
    s_barrier
    s_cmp_lg_u32 s30, 0
    s_cbranch_scc1 QP_14
    s_lshl_b32 s70, s101, 8
    s_add_u32 s70, s70, 32768
    ds_read_b128 v[14:17], v46 offset:1024
    ds_read_b128 v[18:21], v46 offset:3328
    ds_read_b128 v[22:25], v46 offset:5632
    ds_read_b128 v[26:29], v46 offset:7936
    s_waitcnt lgkmcnt(2)
    v_add_f32 v14, v14, v18
    v_add_f32 v15, v15, v19
    v_add_f32 v16, v16, v20
    v_add_f32 v17, v17, v21
    s_waitcnt lgkmcnt(0)
    v_add_f32 v22, v22, v26
    v_add_f32 v23, v23, v27
    v_add_f32 v24, v24, v28
    v_add_f32 v25, v25, v29
    v_add_f32 v14, v14, v22
    v_add_f32 v15, v15, v23
    v_add_f32 v16, v16, v24
    v_add_f32 v17, v17, v25
    v_add_f32_dpp v14, v14, v14 quad_perm:[1,0,3,2] row_mask:0xf bank_mask:0xf
    v_add_f32_dpp v15, v15, v15 quad_perm:[1,0,3,2] row_mask:0xf bank_mask:0xf
    v_add_f32_dpp v16, v16, v16 quad_perm:[1,0,3,2] row_mask:0xf bank_mask:0xf
    v_add_f32_dpp v17, v17, v17 quad_perm:[1,0,3,2] row_mask:0xf bank_mask:0xf
    v_add_f32_dpp v14, v14, v14 quad_perm:[2,3,0,1] row_mask:0xf bank_mask:0xf
    v_add_f32_dpp v15, v15, v15 quad_perm:[2,3,0,1] row_mask:0xf bank_mask:0xf
    v_add_f32_dpp v16, v16, v16 quad_perm:[2,3,0,1] row_mask:0xf bank_mask:0xf
    v_add_f32_dpp v17, v17, v17 quad_perm:[2,3,0,1] row_mask:0xf bank_mask:0xf
    v_cvt_pk_bf16_f32 v14, v14, v14
    v_cvt_pk_bf16_f32 v15, v15, v15
    v_cvt_pk_bf16_f32 v16, v16, v16
    v_cvt_pk_bf16_f32 v17, v17, v17
    s_mov_b32 s79, 0xffff
    v_bfi_b32 v14, s79, v8, v14
    v_bfi_b32 v15, s79, v8, v15
    v_bfi_b32 v16, s79, v8, v16
    v_bfi_b32 v17, s79, v8, v17
    s_mov_b32 exec_lo, 0x11111111
    s_mov_b32 exec_hi, 0x11111111
    buffer_store_dwordx4 v[14:17], v47, s[36:39], s70 offen sc1
    s_mov_b64 exec, -1
QP_14:
    s_mov_b32 s2, s3
    s_cmp_lt_u32 s2, 37
    s_cbranch_scc1 L_m
    s_branch L_f
    .p2alignl 12, 0xbf810000
HF_15:
    s_branch L_retF
L_m:
    s_lshl_b32 s68, s2, 1
    s_add_u32 s68, s68, 54
    s_add_u32 s69, s2, 17
    s_cmp_lt_u32 s2, 3
    s_cselect_b32 s67, 4915200, 0
    s_cselect_b32 s68, s68, s69
    s_cselect_b32 s69, 2, 1
    s_mov_b32 s40, s24
    s_and_b32 s41, s25, 0xffff
    s_mov_b32 s42, 4915200
    s_mov_b32 s43, 0x20000
    s_mov_b32 s44, s24
    s_and_b32 s45, s25, 0xffff
    s_mov_b32 s46, s67
    s_mov_b32 s47, 0x20000
    s_mov_b32 s56, s26
    s_and_b32 s57, s27, 0xffff
    s_mov_b32 s58, 1280
    s_mov_b32 s59, 0x20000
    v_lshrrev_b32 v32, 1, v10
    buffer_load_ushort v12, v32, s[48:51], 0 offen
    v_lshrrev_b32 v32, 3, v1
    v_mul_u32_u24 v11, 38400, v32
    v_and_b32 v32, 7, v1
    v_lshl_add_u32 v11, v32, 4, v11
    s_mul_i32 s62, s30, 307200
    s_lshl_b32 s63, s68, 7
    s_add_u32 s62, s62, s63
    s_add_u32 s64, s62, 128
    s_waitcnt vmcnt(2)
    buffer_load_dwordx4 v[88:91], v11, s[40:43], s62 offen offset:0 nt
    s_waitcnt vmcnt(2)
    s_add_u32 s61, s62, 7680
    buffer_load_dwordx4 v[92:95], v11, s[40:43], s61 offen nt
    s_waitcnt vmcnt(2)
    s_add_u32 s61, s62, 15360
    buffer_load_dwordx4 v[96:99], v11, s[40:43], s61 offen nt
    s_waitcnt vmcnt(2)
    s_add_u32 s61, s62, 23040
    buffer_load_dwordx4 v[100:103], v11, s[40:43], s61 offen nt
    s_waitcnt vmcnt(2)
    s_add_u32 s61, s62, 30720
    buffer_load_dwordx4 v[104:107], v11, s[40:43], s61 offen nt
    s_waitcnt vmcnt(2)
    buffer_load_dwordx4 v[108:111], v11, s[44:47], s64 offen offset:0 nt
    s_waitcnt vmcnt(2)
    s_add_u32 s61, s64, 7680
    buffer_load_dwordx4 v[112:115], v11, s[44:47], s61 offen nt
    s_waitcnt vmcnt(2)
    s_add_u32 s61, s64, 15360
    buffer_load_dwordx4 v[116:119], v11, s[44:47], s61 offen nt
    s_waitcnt vmcnt(2)
    s_add_u32 s61, s64, 23040
    buffer_load_dwordx4 v[120:123], v11, s[44:47], s61 offen nt
    s_waitcnt vmcnt(2)
    s_add_u32 s61, s64, 30720
    buffer_load_dwordx4 v[124:127], v11, s[44:47], s61 offen nt
    s_waitcnt vmcnt(10)
    v_lshlrev_b32 v12, 16, v12
    v_mul_f32 v32, 0xbfb8aa3b, v12
    v_exp_f32 v32, v32
    s_nop 0
    v_add_f32 v32, 1.0, v32
    v_min_f32 v32, 0x7f61b1e6, v32
    v_rcp_f32 v33, v32
    s_nop 0
    v_mul_f32 v34, v12, v33
    v_fma_f32 v35, -v34, v32, v12
    v_fma_f32 v12, v35, v33, v34
    v_cvt_pk_bf16_f32 v12, v12, v12
    s_nop 1
    v_and_b32_dpp v48, v12, v0 row_newbcast:0 row_mask:0xf bank_mask:0x3
    s_nop 1
    v_and_b32_dpp v48, v12, v0 row_newbcast:8 row_mask:0xf bank_mask:0xc
    v_pk_mul_f32 v[14:15], v[48:49], v[4:5] op_sel:[0,0] op_sel_hi:[0,1]
    v_pk_mul_f32 v[16:17], v[48:49], v[6:7] op_sel:[0,0] op_sel_hi:[0,1]
    v_and_b32_dpp v50, v12, v0 row_newbcast:1 row_mask:0xf bank_mask:0x3
    s_nop 1
    v_and_b32_dpp v50, v12, v0 row_newbcast:9 row_mask:0xf bank_mask:0xc
    v_pk_mul_f32 v[18:19], v[50:51], v[4:5] op_sel:[0,0] op_sel_hi:[0,1]
    v_pk_mul_f32 v[20:21], v[50:51], v[6:7] op_sel:[0,0] op_sel_hi:[0,1]
    s_waitcnt vmcnt(4)
    v_mfma_f32_16x16x32_bf16 v[22:25], v[88:91], v[14:17], 0
    v_mfma_f32_16x16x32_bf16 v[26:29], v[108:111], v[14:17], 0
    v_and_b32_dpp v48, v12, v0 row_newbcast:2 row_mask:0xf bank_mask:0x3
    s_nop 1
    v_and_b32_dpp v48, v12, v0 row_newbcast:10 row_mask:0xf bank_mask:0xc
    v_pk_mul_f32 v[14:15], v[48:49], v[4:5] op_sel:[0,0] op_sel_hi:[0,1]
    v_pk_mul_f32 v[16:17], v[48:49], v[6:7] op_sel:[0,0] op_sel_hi:[0,1]
    s_waitcnt vmcnt(3)
    v_mfma_f32_16x16x32_bf16 v[22:25], v[92:95], v[18:21], v[22:25]
    v_mfma_f32_16x16x32_bf16 v[26:29], v[112:115], v[18:21], v[26:29]
    v_and_b32_dpp v50, v12, v0 row_newbcast:3 row_mask:0xf bank_mask:0x3
    s_nop 1
    v_and_b32_dpp v50, v12, v0 row_newbcast:11 row_mask:0xf bank_mask:0xc
    v_pk_mul_f32 v[18:19], v[50:51], v[4:5] op_sel:[0,0] op_sel_hi:[0,1]
    v_pk_mul_f32 v[20:21], v[50:51], v[6:7] op_sel:[0,0] op_sel_hi:[0,1]
    s_waitcnt vmcnt(2)
    v_mfma_f32_16x16x32_bf16 v[22:25], v[96:99], v[14:17], v[22:25]
    v_mfma_f32_16x16x32_bf16 v[26:29], v[116:119], v[14:17], v[26:29]
    v_and_b32_dpp v48, v12, v0 row_newbcast:4 row_mask:0xf bank_mask:0x3
    s_nop 1
    v_and_b32_dpp v48, v12, v0 row_newbcast:12 row_mask:0xf bank_mask:0xc
    v_pk_mul_f32 v[14:15], v[48:49], v[4:5] op_sel:[0,0] op_sel_hi:[0,1]
    v_pk_mul_f32 v[16:17], v[48:49], v[6:7] op_sel:[0,0] op_sel_hi:[0,1]
    s_waitcnt vmcnt(1)
    v_mfma_f32_16x16x32_bf16 v[22:25], v[100:103], v[18:21], v[22:25]
    v_mfma_f32_16x16x32_bf16 v[26:29], v[120:123], v[18:21], v[26:29]
    s_waitcnt vmcnt(0)
    v_mfma_f32_16x16x32_bf16 v[22:25], v[104:107], v[14:17], v[22:25]
    v_mfma_f32_16x16x32_bf16 v[26:29], v[124:127], v[14:17], v[26:29]
    s_nop 6
    v_permlane32_swap_b32 v22, v23
    v_permlane32_swap_b32 v24, v25
    v_permlane32_swap_b32 v26, v27
    v_permlane32_swap_b32 v28, v29
    v_add_f32_dpp v30, v23, v22 row_ror:8 row_mask:0xf bank_mask:0x3
    s_nop 1
    v_add_f32_dpp v30, v26, v27 row_ror:8 row_mask:0xf bank_mask:0xc
    v_add_f32_dpp v31, v25, v24 row_ror:8 row_mask:0xf bank_mask:0x3
    s_nop 1
    v_add_f32_dpp v31, v28, v29 row_ror:8 row_mask:0xf bank_mask:0xc
    ds_write_b32 v45, v30 offset:10240
    ds_write_b32 v45, v31 offset:10496
    s_waitcnt lgkmcnt(0)
    s_barrier
    s_cmp_eq_u32 s30, 2
    s_cbranch_scc1 L_red
    s_cmp_ge_u32 s30, s69
    s_cbranch_scc1 L_end
    s_add_u32 s70, s68, s30
    s_lshl_b32 s70, s70, 8
    s_add_u32 s70, s70, 4096
    s_lshl_b32 s71, s30, 5
    v_add_u32 v33, s71, v46
    ds_read_b128 v[88:91], v33 offset:10240
    ds_read_b128 v[92:95], v33 offset:12544
    ds_read_b128 v[96:99], v33 offset:14848
    ds_read_b128 v[100:103], v33 offset:17152
    s_waitcnt lgkmcnt(2)
    v_add_f32 v88, v88, v92
    v_add_f32 v89, v89, v93
    v_add_f32 v90, v90, v94
    v_add_f32 v91, v91, v95
    s_waitcnt lgkmcnt(0)
    v_add_f32 v96, v96, v100
    v_add_f32 v97, v97, v101
    v_add_f32 v98, v98, v102
    v_add_f32 v99, v99, v103
    v_add_f32 v88, v88, v96
    v_add_f32 v89, v89, v97
    v_add_f32 v90, v90, v98
    v_add_f32 v91, v91, v99
    v_add_f32_dpp v88, v88, v88 quad_perm:[1,0,3,2] row_mask:0xf bank_mask:0xf
    v_add_f32_dpp v89, v89, v89 quad_perm:[1,0,3,2] row_mask:0xf bank_mask:0xf
    v_add_f32_dpp v90, v90, v90 quad_perm:[1,0,3,2] row_mask:0xf bank_mask:0xf
    v_add_f32_dpp v91, v91, v91 quad_perm:[1,0,3,2] row_mask:0xf bank_mask:0xf
    v_add_f32_dpp v88, v88, v88 quad_perm:[2,3,0,1] row_mask:0xf bank_mask:0xf
    v_add_f32_dpp v89, v89, v89 quad_perm:[2,3,0,1] row_mask:0xf bank_mask:0xf
    v_add_f32_dpp v90, v90, v90 quad_perm:[2,3,0,1] row_mask:0xf bank_mask:0xf
    v_add_f32_dpp v91, v91, v91 quad_perm:[2,3,0,1] row_mask:0xf bank_mask:0xf
    v_cvt_pk_bf16_f32 v88, v88, v88
    v_cvt_pk_bf16_f32 v89, v89, v89
    v_cvt_pk_bf16_f32 v90, v90, v90
    v_cvt_pk_bf16_f32 v91, v91, v91
    s_mov_b32 s79, 0xffff
    v_bfi_b32 v88, s79, v8, v88
    v_bfi_b32 v89, s79, v8, v89
    v_bfi_b32 v90, s79, v8, v90
    v_bfi_b32 v91, s79, v8, v91
    s_mov_b32 exec_lo, 0x11111111
    s_mov_b32 exec_hi, 0x11111111
    buffer_store_dwordx4 v[88:91], v47, s[36:39], s70 offen sc1
    s_mov_b64 exec, -1
    s_endpgm
L_race:
    s_mov_b32 s60, s69
    s_lshl_b32 s61, s60, 8
    s_add_u32 s61, s61, 442368
    s_add_u32 s62, s61, 0x2000
    s_add_u32 s63, s61, 0x2080
    s_add_u32 s64, s61, 0x80
    s_load_dword s65, s[28:29], s61
    s_load_dword s66, s[28:29], s62
    s_waitcnt lgkmcnt(1)
    s_getreg_b32 s67, hwreg(HW_REG_IB_STS, 8, 1)
    s_waitcnt lgkmcnt(0)
    s_load_dword s65, s[28:29], s63
    s_load_dword s66, s[28:29], s64
    s_waitcnt lgkmcnt(1)
    s_getreg_b32 s68, hwreg(HW_REG_IB_STS, 8, 1)
    s_waitcnt lgkmcnt(0)
    s_getreg_b32 s65, hwreg(HW_REG_XCC_ID, 2, 1)
    s_xor_b32 s66, s65, 1
    s_lshl_b32 s67, s67, s65
    s_lshl_b32 s68, s68, s66
    s_or_b32 s67, s67, s68
    s_lshl_b32 s68, s31, 2
    s_or_b32 s67, s67, s68
    s_lshl_b32 s60, s60, 2
    s_add_u32 s60, s60, 20480
    v_mov_b32 v32, s67
    v_mov_b32 v33, 0
    s_mov_b32 exec_lo, 0x1
    s_mov_b32 exec_hi, 0x0
    buffer_store_dword v32, v33, s[36:39], s60 offen sc1
    s_mov_b64 exec, -1
    s_endpgm
HF_16:
    s_branch L_retF
L_red:
    s_cmp_ge_u32 s2, 20
    s_cbranch_scc1 L_end
    v_and_b32 v32, 3, v3
    v_lshlrev_b32 v32, 3, v32
    v_and_or_b32 v38, v3, 4, v32
    v_add_u32 v10, v38, v2
    s_lshl_b32 s62, s2, 5
    v_add_u32 v10, s62, v10
    v_lshlrev_b32 v33, 1, v10
    v_lshlrev_b32 v10, 2, v10
    buffer_load_ushort v13, v33, s[52:55], 0 offen
    buffer_load_ushort v64, v33, s[56:59], 0 offen
    s_mov_b32 s63, 9216
    s_mov_b32 s64, 16896
    s_mov_b32 s75, 20480
    v_lshlrev_b32 v35, 2, v1
    buffer_load_dword v36, v35, s[36:39], s75 offen sc1
    s_mov_b32 s34, 0
PG_17:
    buffer_load_dword v11, v10, s[36:39], s63 offen sc1
    buffer_load_dword v12, v10, s[36:39], s64 offen sc1
    s_waitcnt vmcnt(0)
    v_xor_b32 v11, v11, v8
    v_xor_b32 v12, v12, v8
    v_or_b32 v34, v11, v12
    v_and_b32 v34, 0xffff, v34
    v_cmp_ne_u32 vcc, 0, v34
    s_nop 0
    s_cbranch_vccz PGd_18
    s_add_u32 s34, s34, 1
    s_cmp_lt_u32 s34, 30000
    s_cbranch_scc1 PG_17
PGd_18:
    s_lshl_b32 s76, s31, 2
    s_or_b32 s77, s76, 1
    s_or_b32 s76, s76, 2
    v_cmp_eq_u32 vcc, s77, v36
    s_bcnt1_i32_b64 s77, vcc
    v_cmp_eq_u32 vcc, s76, v36
    s_bcnt1_i32_b64 s76, vcc
    s_cmp_gt_u32 s76, s77
    s_cselect_b32 s77, 1, 0
    s_getreg_b32 s76, hwreg(HW_REG_XCC_ID, 2, 1)
    s_xor_b32 s76, s76, s77
    s_lshl_b32 s74, s76, 13
    s_lshl_b32 s65, s2, 7
    s_add_u32 s65, s65, s74
    s_add_u32 s65, s65, 262144
    s_add_u32 s66, s65, 0x10000
    v_lshlrev_b32 v38, 2, v38
    v_lshl_add_u32 v38, v2, 14, v38
    v_lshrrev_b32 v34, 3, v3
    v_mul_u32_u24 v34, 2560, v34
    v_add_u32 v38, v38, v34
    s_mov_b32 s34, 0
PA_19:
    buffer_load_dwordx4 v[14:17], v38, s[36:39], s65 offen sc1
    buffer_load_dwordx4 v[18:21], v38, s[36:39], s66 offen sc1
    s_waitcnt vmcnt(0)
    v_xor_b32 v14, v14, v9
    v_xor_b32 v18, v18, v9
    v_or_b32 v34, v14, v18
    v_and_b32 v34, 0x3ff, v34
    v_cmp_ne_u32 vcc, 0, v34
    s_nop 0
    s_cbranch_vccz PAd_20
    s_add_u32 s34, s34, 1
    s_cmp_lt_u32 s34, 30000
    s_cbranch_scc1 PA_19
    s_branch PAd_20
HF_21:
    s_branch L_retF
PAd_20:
    v_lshlrev_b32 v13, 16, v13
    v_add_f32 v14, v14, v18
    v_add_f32 v15, v15, v19
    v_add_f32 v16, v16, v20
    v_add_f32 v17, v17, v21
    s_nop 0
    v_permlane32_swap_b32 v14, v16
    v_permlane32_swap_b32 v15, v17
    v_add_f32 v14, v14, v16
    v_add_f32 v15, v15, v17
    s_nop 1
    v_permlane16_swap_b32 v14, v15
    v_add_f32 v14, v14, v15
    s_nop 1
    v_add_f32_dpp v14, v14, v14 row_ror:8 row_mask:0xf bank_mask:0xf
    v_cvt_pk_bf16_f32 v14, 0, v14
    v_mul_f32 v14, v11, v14
    v_cvt_pk_bf16_f32 v14, 0, v14
    v_add_f32 v14, v13, v14
    v_cvt_pk_bf16_f32 v14, 0, v14
    v_lshlrev_b32 v34, 4, v1
    v_min_u32 v35, 368, v34
    v_cmp_gt_u32 vcc, 24, v1
    s_nop 1
    v_cndmask_b32 v36, 0, 1.0, vcc
    s_lshr_b32 s62, s2, 1
    s_mul_i32 s62, s62, 16512
    s_and_b32 s63, s2, 1
    s_mul_i32 s63, s63, 3456
    s_add_u32 s62, s62, s63
    s_add_u32 s62, s62, s74
    s_add_u32 s62, s62, 589824
    buffer_load_dwordx4 v[48:51], v34, s[36:39], s62 offen offset:0 sc1
    buffer_load_dwordx4 v[52:55], v34, s[36:39], s62 offen offset:1024 sc1
    buffer_load_dwordx4 v[56:59], v34, s[36:39], s62 offen offset:2048 sc1
    buffer_load_dwordx4 v[60:63], v35, s[36:39], s62 offen offset:3072 sc1
    buffer_load_dwordx4 v[64:67], v34, s[36:39], s62 offen offset:0 sc1
    buffer_load_dwordx4 v[68:71], v34, s[36:39], s62 offen offset:1024 sc1
    buffer_load_dwordx4 v[72:75], v34, s[36:39], s62 offen offset:2048 sc1
    buffer_load_dwordx4 v[76:79], v35, s[36:39], s62 offen offset:3072 sc1
    buffer_load_dwordx4 v[80:83], v34, s[36:39], s62 offen offset:0 sc1
    buffer_load_dwordx4 v[84:87], v34, s[36:39], s62 offen offset:1024 sc1
    buffer_load_dwordx4 v[88:91], v34, s[36:39], s62 offen offset:2048 sc1
    buffer_load_dwordx4 v[92:95], v35, s[36:39], s62 offen offset:3072 sc1
    s_mov_b32 s34, 0
L_pd:
    s_waitcnt vmcnt(8)
    v_xor_b32 v48, v48, v9
    v_xor_b32 v52, v52, v9
    v_xor_b32 v56, v56, v9
    v_xor_b32 v60, v60, v9
    v_or3_b32 v37, v48, v52, v56
    v_or_b32 v37, v37, v60
    v_and_b32 v37, 0x3ff, v37
    v_cmp_ne_u32 vcc, 0, v37
    s_nop 0
    s_cbranch_vccz L_pd0
    buffer_load_dwordx4 v[48:51], v34, s[36:39], s62 offen offset:0 sc1
    buffer_load_dwordx4 v[52:55], v34, s[36:39], s62 offen offset:1024 sc1
    buffer_load_dwordx4 v[56:59], v34, s[36:39], s62 offen offset:2048 sc1
    buffer_load_dwordx4 v[60:63], v35, s[36:39], s62 offen offset:3072 sc1
    s_waitcnt vmcnt(8)
    v_xor_b32 v64, v64, v9
    v_xor_b32 v68, v68, v9
    v_xor_b32 v72, v72, v9
    v_xor_b32 v76, v76, v9
    v_or3_b32 v37, v64, v68, v72
    v_or_b32 v37, v37, v76
    v_and_b32 v37, 0x3ff, v37
    v_cmp_ne_u32 vcc, 0, v37
    s_nop 0
    s_cbranch_vccz L_pd1
    buffer_load_dwordx4 v[64:67], v34, s[36:39], s62 offen offset:0 sc1
    buffer_load_dwordx4 v[68:71], v34, s[36:39], s62 offen offset:1024 sc1
    buffer_load_dwordx4 v[72:75], v34, s[36:39], s62 offen offset:2048 sc1
    buffer_load_dwordx4 v[76:79], v35, s[36:39], s62 offen offset:3072 sc1
    s_waitcnt vmcnt(8)
    v_xor_b32 v80, v80, v9
    v_xor_b32 v84, v84, v9
    v_xor_b32 v88, v88, v9
    v_xor_b32 v92, v92, v9
    v_or3_b32 v37, v80, v84, v88
    v_or_b32 v37, v37, v92
    v_and_b32 v37, 0x3ff, v37
    v_cmp_ne_u32 vcc, 0, v37
    s_nop 0
    s_cbranch_vccz L_pd2
    buffer_load_dwordx4 v[80:83], v34, s[36:39], s62 offen offset:0 sc1
    buffer_load_dwordx4 v[84:87], v34, s[36:39], s62 offen offset:1024 sc1
    buffer_load_dwordx4 v[88:91], v34, s[36:39], s62 offen offset:2048 sc1
    buffer_load_dwordx4 v[92:95], v35, s[36:39], s62 offen offset:3072 sc1
    s_add_u32 s34, s34, 1
    s_cmp_lt_u32 s34, 30000
    s_cbranch_scc1 L_pd
    s_branch L_pd0
HF_22:
    s_branch L_retF
L_pd0:
    v_add_f32 v22, v48, v52
    v_add_f32 v23, v49, v53
    v_add_f32 v24, v50, v54
    v_add_f32 v25, v51, v55
    v_fma_f32 v26, v60, v36, v56
    v_fma_f32 v27, v61, v36, v57
    v_fma_f32 v28, v62, v36, v58
    v_fma_f32 v29, v63, v36, v59
    s_nop 0
    s_branch L_pdx
L_pd1:
    v_add_f32 v22, v64, v68
    v_add_f32 v23, v65, v69
    v_add_f32 v24, v66, v70
    v_add_f32 v25, v67, v71
    v_fma_f32 v26, v76, v36, v72
    v_fma_f32 v27, v77, v36, v73
    v_fma_f32 v28, v78, v36, v74
    v_fma_f32 v29, v79, v36, v75
    s_nop 0
    s_branch L_pdx
L_pd2:
    v_add_f32 v22, v80, v84
    v_add_f32 v23, v81, v85
    v_add_f32 v24, v82, v86
    v_add_f32 v25, v83, v87
    v_fma_f32 v26, v92, v36, v88
    v_fma_f32 v27, v93, v36, v89
    v_fma_f32 v28, v94, v36, v90
    v_fma_f32 v29, v95, v36, v91
L_pdx:
    v_add_f32 v22, v22, v26
    v_add_f32 v23, v23, v27
    v_add_f32 v24, v24, v28
    v_add_f32 v25, v25, v29
    s_nop 0
    v_permlane32_swap_b32 v22, v24
    v_permlane32_swap_b32 v23, v25
    v_add_f32 v22, v22, v24
    v_add_f32 v23, v23, v25
    s_nop 1
    v_permlane16_swap_b32 v22, v23
    v_add_f32 v22, v22, v23
    s_nop 1
    v_add_f32_dpp v22, v22, v22 row_ror:8 row_mask:0xf bank_mask:0xf
    v_cvt_pk_bf16_f32 v22, 0, v22
    v_mul_f32 v22, v12, v22
    v_cvt_pk_bf16_f32 v22, 0, v22
    v_add_f32 v22, v14, v22
    v_cvt_pk_bf16_f32 v22, v22, v22
    s_mov_b32 exec_lo, 0xff00ff
    s_mov_b32 exec_hi, 0xff00ff
    buffer_store_short v22, v33, s[56:59], 0 offen
    s_mov_b64 exec, -1
    s_endpgm
HA_23:
    s_branch L_retA
L_att:
    s_add_u32 s62, s61, 1024
    s_sub_u32 s71, s62, 11264
    s_min_u32 s62, s62, s71
    s_add_u32 s63, s62, 1024
    s_sub_u32 s71, s63, 11264
    s_min_u32 s63, s63, s71
    s_add_u32 s64, s63, 1024
    s_sub_u32 s71, s64, 11264
    s_min_u32 s64, s64, s71
    s_add_u32 s65, s64, 1024
    s_sub_u32 s71, s65, 11264
    s_min_u32 s65, s65, s71
    s_add_u32 s66, s65, 1024
    s_sub_u32 s71, s66, 11264
    s_min_u32 s66, s66, s71
    s_add_u32 s67, s66, 1024
    s_sub_u32 s71, s67, 11264
    s_min_u32 s67, s67, s71
    s_add_u32 s68, s67, 1024
    s_sub_u32 s71, s68, 11264
    s_min_u32 s68, s68, s71
    s_add_u32 s69, s68, 1024
    s_sub_u32 s71, s69, 11264
    s_min_u32 s69, s69, s71
    s_add_u32 s70, s69, 1024
    s_sub_u32 s71, s70, 11264
    s_min_u32 s70, s70, s71
    v_and_b32 v1, 63, v0
    v_bfe_u32 v2, v0, 4, 2
    v_and_b32 v3, 15, v0
    s_sub_u32 s3, s2, 64
    s_sub_u32 s101, s101, 2
    s_sub_u32 s75, s42, s74
    s_mov_b32 s46, s42
    s_mov_b32 s47, 0x20000
    s_mov_b32 s38, 917504
    s_mov_b32 s39, 0x20000
    v_mov_b32 v21, 0
    ds_write_b32 v21, v21 offset:256
    ds_write_b32 v21, v21 offset:260
    ds_write_b32 v21, v21 offset:640
    v_mov_b32 v22, 23
    s_and_b32 s71, s3, 7
    s_lshl_b32 s71, s71, 5
    v_mov_b32 v23, s71
    v_and_b32 v24, 1, v3
    v_lshlrev_b32 v24, 4, v24
    v_mov_b32 v25, 0xffff
    v_lshlrev_b32 v0, v24, v25
    v_bfe_u32 v25, v3, 1, 2
    v_cmp_eq_u32 vcc, 0, v25
    s_nop 1
    v_cndmask_b32 v4, 0, 1.0, vcc
    v_cmp_eq_u32 vcc, 1, v25
    s_nop 1
    v_cndmask_b32 v5, 0, 1.0, vcc
    v_cmp_eq_u32 vcc, 2, v25
    s_nop 1
    v_cndmask_b32 v6, 0, 1.0, vcc
    v_cmp_eq_u32 vcc, 3, v25
    s_nop 1
    v_cndmask_b32 v7, 0, 1.0, vcc
    s_waitcnt lgkmcnt(0)
    s_add_u32 s31, s31, 1
    s_and_b32 s32, s31, 0xffff
    s_and_b32 s33, s31, 0x3ff
    v_mov_b32 v8, s32
    v_mov_b32 v9, s33
    s_mov_b32 s35, 0x3ff
    s_barrier
L_att_a2:
    s_waitcnt vmcnt(0)
    buffer_load_dwordx4 v[40:43], v20, s[40:43], s62 offen nt
L_att_a3:
    s_waitcnt vmcnt(0)
    buffer_load_dwordx4 v[44:47], v20, s[40:43], s63 offen nt
    s_cmp_eq_u32 s30, 0
    s_cbranch_scc1 L_att_w0
L_att_a4:
    s_waitcnt vmcnt(1)
    buffer_load_dwordx4 v[48:51], v20, s[40:43], s64 offen nt
L_att_a5:
    s_waitcnt vmcnt(1)
    buffer_load_dwordx4 v[52:55], v20, s[40:43], s65 offen nt
L_att_a6:
    s_waitcnt vmcnt(1)
    buffer_load_dwordx4 v[56:59], v20, s[40:43], s66 offen nt
L_att_a7:
    s_waitcnt vmcnt(1)
    buffer_load_dwordx4 v[60:63], v20, s[40:43], s67 offen nt
L_att_a8:
    s_waitcnt vmcnt(1)
    buffer_load_dwordx4 v[64:67], v20, s[40:43], s68 offen nt
L_att_a9:
    s_waitcnt vmcnt(1)
    buffer_load_dwordx4 v[68:71], v20, s[40:43], s69 offen nt
L_att_a10:
    s_waitcnt vmcnt(1)
    buffer_load_dwordx4 v[72:75], v20, s[40:43], s70 offen nt
L_att_a11:
    s_waitcnt vmcnt(1)
    buffer_load_dwordx4 v[76:79], v20, s[44:47], s60 offen nt
L_att_a12:
    s_waitcnt vmcnt(1)
    buffer_load_dwordx4 v[80:83], v20, s[44:47], s61 offen nt
    ds_read_b32 v24, v21 offset:256
    s_waitcnt lgkmcnt(0)
    v_cmp_ne_u32 vcc, 0, v24
    s_nop 0
    s_cbranch_vccnz L_att_b12
L_att_a13:
    s_waitcnt vmcnt(1)
    buffer_load_dwordx4 v[84:87], v20, s[44:47], s62 offen nt
    ds_read_b32 v24, v21 offset:256
    s_waitcnt lgkmcnt(0)
    v_cmp_ne_u32 vcc, 0, v24
    s_nop 0
    s_cbranch_vccnz L_att_b13
L_att_a14:
    s_waitcnt vmcnt(1)
    buffer_load_dwordx4 v[88:91], v20, s[44:47], s63 offen nt
    ds_read_b32 v24, v21 offset:256
    s_waitcnt lgkmcnt(0)
    v_cmp_ne_u32 vcc, 0, v24
    s_nop 0
    s_cbranch_vccnz L_att_b14
L_att_a15:
    s_waitcnt vmcnt(1)
    buffer_load_dwordx4 v[92:95], v20, s[44:47], s64 offen nt
    ds_read_b32 v24, v21 offset:256
    s_waitcnt lgkmcnt(0)
    v_cmp_ne_u32 vcc, 0, v24
    s_nop 0
    s_cbranch_vccnz L_att_b15
L_att_a16:
    s_waitcnt vmcnt(1)
    buffer_load_dwordx4 v[96:99], v20, s[44:47], s65 offen nt
    ds_read_b32 v24, v21 offset:256
    s_waitcnt lgkmcnt(0)
    v_cmp_ne_u32 vcc, 0, v24
    s_nop 0
    s_cbranch_vccnz L_att_b16
L_att_a17:
    s_waitcnt vmcnt(1)
    buffer_load_dwordx4 v[100:103], v20, s[44:47], s66 offen nt
    ds_read_b32 v24, v21 offset:256
    s_waitcnt lgkmcnt(0)
    v_cmp_ne_u32 vcc, 0, v24
    s_nop 0
    s_cbranch_vccnz L_att_b17
L_att_a18:
    s_waitcnt vmcnt(1)
    buffer_load_dwordx4 v[104:107], v20, s[44:47], s67 offen nt
    ds_read_b32 v24, v21 offset:256
    s_waitcnt lgkmcnt(0)
    v_cmp_ne_u32 vcc, 0, v24
    s_nop 0
    s_cbranch_vccnz L_att_b18
L_att_a19:
    s_waitcnt vmcnt(1)
    buffer_load_dwordx4 v[108:111], v20, s[44:47], s68 offen nt
    ds_read_b32 v24, v21 offset:256
    s_waitcnt lgkmcnt(0)
    v_cmp_ne_u32 vcc, 0, v24
    s_nop 0
    s_cbranch_vccnz L_att_b19
L_att_a20:
    s_waitcnt vmcnt(1)
    buffer_load_dwordx4 v[112:115], v20, s[44:47], s69 offen nt
    ds_read_b32 v24, v21 offset:256
    s_waitcnt lgkmcnt(0)
    v_cmp_ne_u32 vcc, 0, v24
    s_nop 0
    s_cbranch_vccnz L_att_b20
L_att_a21:
    s_waitcnt vmcnt(1)
    buffer_load_dwordx4 v[116:119], v20, s[44:47], s70 offen nt
    s_cmp_lg_u32 s30, 1
    s_cbranch_scc1 TK_24
    s_mov_b64 exec, 1
    global_atomic_inc v22, v23, v22, s[52:53] sc0 sc1
    s_mov_b64 exec, -1
TK_24:
L_att_a22:
    s_mov_b32 s76, 21
    s_mov_b32 s34, 0
L_att_spin:
    ds_read_b32 v24, v21 offset:256
    s_waitcnt lgkmcnt(0)
    v_cmp_ne_u32 vcc, 0, v24
    s_nop 0
    s_cbranch_vccnz L_att_qk
    s_add_u32 s34, s34, 1
    s_cmp_lt_u32 s34, 480000
    s_cbranch_scc1 L_att_spin
    s_branch L_att_qk
HA_25:
    s_branch L_retA
L_att_b12:
    buffer_load_dwordx4 v[84:87], v20, s[44:47], s62 offen nt
    buffer_load_dwordx4 v[88:91], v20, s[44:47], s63 offen nt
    s_mov_b32 s76, 14
    s_branch L_att_qk
L_att_b13:
    buffer_load_dwordx4 v[88:91], v20, s[44:47], s63 offen nt
    buffer_load_dwordx4 v[92:95], v20, s[44:47], s64 offen nt
    s_mov_b32 s76, 15
    s_branch L_att_qk
L_att_b14:
    buffer_load_dwordx4 v[92:95], v20, s[44:47], s64 offen nt
    buffer_load_dwordx4 v[96:99], v20, s[44:47], s65 offen nt
    s_mov_b32 s76, 16
    s_branch L_att_qk
L_att_b15:
    buffer_load_dwordx4 v[96:99], v20, s[44:47], s65 offen nt
    buffer_load_dwordx4 v[100:103], v20, s[44:47], s66 offen nt
    s_mov_b32 s76, 17
    s_branch L_att_qk
L_att_b16:
    buffer_load_dwordx4 v[100:103], v20, s[44:47], s66 offen nt
    buffer_load_dwordx4 v[104:107], v20, s[44:47], s67 offen nt
    s_mov_b32 s76, 18
    s_branch L_att_qk
L_att_b17:
    buffer_load_dwordx4 v[104:107], v20, s[44:47], s67 offen nt
    buffer_load_dwordx4 v[108:111], v20, s[44:47], s68 offen nt
    s_mov_b32 s76, 19
    s_branch L_att_qk
L_att_b18:
    buffer_load_dwordx4 v[108:111], v20, s[44:47], s68 offen nt
    buffer_load_dwordx4 v[112:115], v20, s[44:47], s69 offen nt
    s_mov_b32 s76, 20
    s_branch L_att_qk
L_att_b19:
    buffer_load_dwordx4 v[112:115], v20, s[44:47], s69 offen nt
    buffer_load_dwordx4 v[116:119], v20, s[44:47], s70 offen nt
    s_cmp_lg_u32 s30, 1
    s_cbranch_scc1 TK_26
    s_mov_b64 exec, 1
    global_atomic_inc v22, v23, v22, s[52:53] sc0 sc1
    s_mov_b64 exec, -1
TK_26:
    s_mov_b32 s76, 21
    s_branch L_att_qk
L_att_b20:
    buffer_load_dwordx4 v[116:119], v20, s[44:47], s70 offen nt
    s_cmp_lg_u32 s30, 1
    s_cbranch_scc1 TK_27
    s_mov_b64 exec, 1
    global_atomic_inc v22, v23, v22, s[52:53] sc0 sc1
    s_mov_b64 exec, -1
TK_27:
    s_mov_b32 s76, 21
    s_branch L_att_qk
L_att_w0:
    s_setprio 3
    v_lshlrev_b32 v26, 3, v1
    s_lshl_b32 s76, s100, 9
    s_add_u32 s76, s76, 32768
    v_lshlrev_b32 v27, 2, v1
    v_mov_b32 v28, 1
    s_mov_b32 s77, 0x07060302
    s_waitcnt vmcnt(1)
    buffer_load_dwordx2 v[22:23], v26, s[36:39], s76 offen sc1
    buffer_load_dwordx4 v[48:51], v20, s[40:43], s64 offen nt
    buffer_load_dwordx4 v[52:55], v20, s[40:43], s65 offen nt
    buffer_load_dwordx4 v[56:59], v20, s[40:43], s66 offen nt
    s_waitcnt vmcnt(3)
    v_xor_b32 v22, v22, v8
    v_xor_b32 v23, v23, v8
    v_or_b32 v24, v22, v23
    v_and_b32 v24, 0xffff, v24
    v_cmp_ne_u32 vcc, 0, v24
    s_nop 0
    s_cbranch_vccz L_att_got7
    buffer_load_dwordx2 v[22:23], v26, s[36:39], s76 offen sc1
    buffer_load_dwordx4 v[60:63], v20, s[40:43], s67 offen nt
    buffer_load_dwordx4 v[64:67], v20, s[40:43], s68 offen nt
    buffer_load_dwordx4 v[68:71], v20, s[40:43], s69 offen nt
    s_waitcnt vmcnt(3)
    v_xor_b32 v22, v22, v8
    v_xor_b32 v23, v23, v8
    v_or_b32 v24, v22, v23
    v_and_b32 v24, 0xffff, v24
    v_cmp_ne_u32 vcc, 0, v24
    s_nop 0
    s_cbranch_vccz L_att_got10
    buffer_load_dwordx2 v[22:23], v26, s[36:39], s76 offen sc1
    buffer_load_dwordx4 v[72:75], v20, s[40:43], s70 offen nt
    buffer_load_dwordx4 v[76:79], v20, s[44:47], s60 offen nt
    buffer_load_dwordx4 v[80:83], v20, s[44:47], s61 offen nt
    s_waitcnt vmcnt(3)
    v_xor_b32 v22, v22, v8
    v_xor_b32 v23, v23, v8
    v_or_b32 v24, v22, v23
    v_and_b32 v24, 0xffff, v24
    v_cmp_ne_u32 vcc, 0, v24
    s_nop 0
    s_cbranch_vccz L_att_got13
    buffer_load_dwordx2 v[22:23], v26, s[36:39], s76 offen sc1
    buffer_load_dwordx4 v[84:87], v20, s[44:47], s62 offen nt
    buffer_load_dwordx4 v[88:91], v20, s[44:47], s63 offen nt
    buffer_load_dwordx4 v[92:95], v20, s[44:47], s64 offen nt
    s_waitcnt vmcnt(3)
    v_xor_b32 v22, v22, v8
    v_xor_b32 v23, v23, v8
    v_or_b32 v24, v22, v23
    v_and_b32 v24, 0xffff, v24
    v_cmp_ne_u32 vcc, 0, v24
    s_nop 0
    s_cbranch_vccz L_att_got16
    buffer_load_dwordx2 v[22:23], v26, s[36:39], s76 offen sc1
    buffer_load_dwordx4 v[96:99], v20, s[44:47], s65 offen nt
    buffer_load_dwordx4 v[100:103], v20, s[44:47], s66 offen nt
    buffer_load_dwordx4 v[104:107], v20, s[44:47], s67 offen nt
    s_waitcnt vmcnt(3)
    v_xor_b32 v22, v22, v8
    v_xor_b32 v23, v23, v8
    v_or_b32 v24, v22, v23
    v_and_b32 v24, 0xffff, v24
    v_cmp_ne_u32 vcc, 0, v24
    s_nop 0
    s_cbranch_vccz L_att_got19
    buffer_load_dwordx2 v[22:23], v26, s[36:39], s76 offen sc1
    buffer_load_dwordx4 v[108:111], v20, s[44:47], s68 offen nt
    buffer_load_dwordx4 v[112:115], v20, s[44:47], s69 offen nt
    buffer_load_dwordx4 v[116:119], v20, s[44:47], s70 offen nt
    s_mov_b32 s34, 0
PQ_28:
    buffer_load_dwordx2 v[22:23], v26, s[36:39], s76 offen sc1
    s_waitcnt vmcnt(0)
    v_xor_b32 v22, v22, v8
    s_branch BA_62x
    .p2alignl 12, 0xbf810000
BA_62:
    s_branch L_retA
BA_62x:
    v_xor_b32 v23, v23, v8
    v_or_b32 v24, v22, v23
    v_and_b32 v24, 0xffff, v24
    v_cmp_ne_u32 vcc, 0, v24
    s_nop 0
    s_cbranch_vccz PQd_29
    s_add_u32 s34, s34, 1
    s_cmp_lt_u32 s34, 30000
    s_cbranch_scc1 PQ_28
PQd_29:
L_att_got22:
    v_perm_b32 v22, v23, v22, s77
    ds_write_b32 v27, v22 offset:0
    ds_write_b32 v21, v28 offset:256
    s_setprio 0
    s_branch L_att_a22
L_att_got7:
    v_perm_b32 v22, v23, v22, s77
    ds_write_b32 v27, v22 offset:0
    ds_write_b32 v21, v28 offset:256
    s_setprio 0
    s_branch L_att_a7
L_att_got10:
    v_perm_b32 v22, v23, v22, s77
    ds_write_b32 v27, v22 offset:0
    ds_write_b32 v21, v28 offset:256
    s_setprio 0
    s_branch L_att_a10
L_att_got13:
    v_perm_b32 v22, v23, v22, s77
    ds_write_b32 v27, v22 offset:0
    ds_write_b32 v21, v28 offset:256
    s_setprio 0
    s_branch L_att_a13
L_att_got16:
    v_perm_b32 v22, v23, v22, s77
    ds_write_b32 v27, v22 offset:0
    ds_write_b32 v21, v28 offset:256
    s_setprio 0
    s_branch L_att_a16
L_att_got19:
    v_perm_b32 v22, v23, v22, s77
    ds_write_b32 v27, v22 offset:0
    ds_write_b32 v21, v28 offset:256
    s_setprio 0
    s_branch L_att_a19
HA_30:
    s_branch L_retA
L_att_qk:
    v_lshlrev_b32 v24, 4, v3
    ds_read_b128 v[10:13], v24 offset:0
    s_waitcnt lgkmcnt(0)
    v_dot2_f32_bf16 v24, v32, v10, 0
    v_dot2_f32_bf16 v25, v36, v10, 0
    v_dot2_f32_bf16 v24, v33, v11, v24
    v_dot2_f32_bf16 v25, v37, v11, v25
    v_dot2_f32_bf16 v24, v34, v12, v24
    v_dot2_f32_bf16 v25, v38, v12, v25
    v_dot2_f32_bf16 v24, v35, v13, v24
    v_dot2_f32_bf16 v25, v39, v13, v25
    s_nop 1
    v_add_f32_dpp v14, v24, v24 row_ror:8 row_mask:0xf bank_mask:0x3
    s_nop 1
    v_add_f32_dpp v14, v25, v25 row_ror:8 row_mask:0xf bank_mask:0xc
    v_dot2_f32_bf16 v24, v40, v10, 0
    v_dot2_f32_bf16 v25, v44, v10, 0
    v_dot2_f32_bf16 v24, v41, v11, v24
    v_dot2_f32_bf16 v25, v45, v11, v25
    v_dot2_f32_bf16 v24, v42, v12, v24
    v_dot2_f32_bf16 v25, v46, v12, v25
    v_dot2_f32_bf16 v24, v43, v13, v24
    v_dot2_f32_bf16 v25, v47, v13, v25
    s_nop 1
    v_add_f32_dpp v15, v24, v24 row_ror:8 row_mask:0xf bank_mask:0x3
    s_nop 1
    v_add_f32_dpp v15, v25, v25 row_ror:8 row_mask:0xf bank_mask:0xc
    v_dot2_f32_bf16 v24, v48, v10, 0
    v_dot2_f32_bf16 v25, v52, v10, 0
    v_dot2_f32_bf16 v24, v49, v11, v24
    v_dot2_f32_bf16 v25, v53, v11, v25
    v_dot2_f32_bf16 v24, v50, v12, v24
    v_dot2_f32_bf16 v25, v54, v12, v25
    v_dot2_f32_bf16 v24, v51, v13, v24
    v_dot2_f32_bf16 v25, v55, v13, v25
    s_nop 1
    v_add_f32_dpp v16, v24, v24 row_ror:8 row_mask:0xf bank_mask:0x3
    s_nop 1
    v_add_f32_dpp v16, v25, v25 row_ror:8 row_mask:0xf bank_mask:0xc
    v_dot2_f32_bf16 v24, v56, v10, 0
    v_dot2_f32_bf16 v25, v60, v10, 0
    v_dot2_f32_bf16 v24, v57, v11, v24
    v_dot2_f32_bf16 v25, v61, v11, v25
    v_dot2_f32_bf16 v24, v58, v12, v24
    v_dot2_f32_bf16 v25, v62, v12, v25
    v_dot2_f32_bf16 v24, v59, v13, v24
    v_dot2_f32_bf16 v25, v63, v13, v25
    s_nop 1
    v_add_f32_dpp v17, v24, v24 row_ror:8 row_mask:0xf bank_mask:0x3
    s_nop 1
    v_add_f32_dpp v17, v25, v25 row_ror:8 row_mask:0xf bank_mask:0xc
    v_dot2_f32_bf16 v24, v64, v10, 0
    v_dot2_f32_bf16 v25, v68, v10, 0
    v_dot2_f32_bf16 v24, v65, v11, v24
    v_dot2_f32_bf16 v25, v69, v11, v25
    v_dot2_f32_bf16 v24, v66, v12, v24
    v_dot2_f32_bf16 v25, v70, v12, v25
    v_dot2_f32_bf16 v24, v67, v13, v24
    v_dot2_f32_bf16 v25, v71, v13, v25
    s_nop 1
    v_add_f32_dpp v18, v24, v24 row_ror:8 row_mask:0xf bank_mask:0x3
    s_nop 1
    v_add_f32_dpp v18, v25, v25 row_ror:8 row_mask:0xf bank_mask:0xc
    v_dot2_f32_bf16 v24, v72, v10, 0
    v_dot2_f32_bf16 v24, v73, v11, v24
    v_dot2_f32_bf16 v24, v74, v12, v24
    v_dot2_f32_bf16 v24, v75, v13, v24
    s_nop 2
    v_add_f32_dpp v19, v24, v24 row_ror:8 row_mask:0xf bank_mask:0xf
    v_add_f32_dpp v14, v14, v14 quad_perm:[1,0,3,2] row_mask:0xf bank_mask:0xf
    v_add_f32_dpp v15, v15, v15 quad_perm:[1,0,3,2] row_mask:0xf bank_mask:0xf
    v_add_f32_dpp v16, v16, v16 quad_perm:[1,0,3,2] row_mask:0xf bank_mask:0xf
    v_add_f32_dpp v17, v17, v17 quad_perm:[1,0,3,2] row_mask:0xf bank_mask:0xf
    v_add_f32_dpp v18, v18, v18 quad_perm:[1,0,3,2] row_mask:0xf bank_mask:0xf
    v_add_f32_dpp v19, v19, v19 quad_perm:[1,0,3,2] row_mask:0xf bank_mask:0xf
    v_add_f32_dpp v14, v14, v14 quad_perm:[2,3,0,1] row_mask:0xf bank_mask:0xf
    v_add_f32_dpp v15, v15, v15 quad_perm:[2,3,0,1] row_mask:0xf bank_mask:0xf
    v_add_f32_dpp v16, v16, v16 quad_perm:[2,3,0,1] row_mask:0xf bank_mask:0xf
    v_add_f32_dpp v17, v17, v17 quad_perm:[2,3,0,1] row_mask:0xf bank_mask:0xf
    v_add_f32_dpp v18, v18, v18 quad_perm:[2,3,0,1] row_mask:0xf bank_mask:0xf
    v_add_f32_dpp v19, v19, v19 quad_perm:[2,3,0,1] row_mask:0xf bank_mask:0xf
    v_add_f32_dpp v14, v14, v14 row_half_mirror row_mask:0xf bank_mask:0xf
    v_add_f32_dpp v15, v15, v15 row_half_mirror row_mask:0xf bank_mask:0xf
    v_add_f32_dpp v16, v16, v16 row_half_mirror row_mask:0xf bank_mask:0xf
    v_add_f32_dpp v17, v17, v17 row_half_mirror row_mask:0xf bank_mask:0xf
    v_add_f32_dpp v18, v18, v18 row_half_mirror row_mask:0xf bank_mask:0xf
    v_add_f32_dpp v19, v19, v19 row_half_mirror row_mask:0xf bank_mask:0xf
    v_mov_b32 v25, 0xff800000
    v_cvt_pk_bf16_f32 v14, 0, v14
    v_cvt_pk_bf16_f32 v15, 0, v15
    v_cvt_pk_bf16_f32 v16, 0, v16
    v_cvt_pk_bf16_f32 v17, 0, v17
    v_cvt_pk_bf16_f32 v18, 0, v18
    v_cvt_pk_bf16_f32 v19, 0, v19
    v_mul_f32 v14, 0x3db504f3, v14
    v_mul_f32 v15, 0x3db504f3, v15
    v_mul_f32 v16, 0x3db504f3, v16
    v_mul_f32 v17, 0x3db504f3, v17
    v_mul_f32 v18, 0x3db504f3, v18
    v_mul_f32 v19, 0x3db504f3, v19
    v_cvt_pk_bf16_f32 v14, 0, v14
    v_cvt_pk_bf16_f32 v15, 0, v15
    v_cvt_pk_bf16_f32 v16, 0, v16
    v_cvt_pk_bf16_f32 v17, 0, v17
    v_cvt_pk_bf16_f32 v18, 0, v18
    v_cvt_pk_bf16_f32 v19, 0, v19
    s_cmp_lg_u32 s30, 0
    s_cbranch_scc1 MK_31
    s_cmp_lt_u32 s60, s75
    s_cselect_b32 s78, 0x00ff00ff, 0
    s_cmp_lt_u32 s61, s75
    s_cselect_b32 s79, 0xff00ff00, 0
    s_or_b32 s78, s78, s79
    s_mov_b32 vcc_lo, s78
    s_mov_b32 vcc_hi, s78
    v_cndmask_b32 v14, v25, v14, vcc
    s_cmp_lt_u32 s62, s75
    s_cselect_b32 s78, 0x00ff00ff, 0
    s_cmp_lt_u32 s63, s75
    s_cselect_b32 s79, 0xff00ff00, 0
    s_or_b32 s78, s78, s79
    s_mov_b32 vcc_lo, s78
    s_mov_b32 vcc_hi, s78
    v_cndmask_b32 v15, v25, v15, vcc
    s_cmp_lt_u32 s64, s75
    s_cselect_b32 s78, 0x00ff00ff, 0
    s_cmp_lt_u32 s65, s75
    s_cselect_b32 s79, 0xff00ff00, 0
    s_or_b32 s78, s78, s79
    s_mov_b32 vcc_lo, s78
    s_mov_b32 vcc_hi, s78
    v_cndmask_b32 v16, v25, v16, vcc
    s_cmp_lt_u32 s66, s75
    s_cselect_b32 s78, 0x00ff00ff, 0
    s_cmp_lt_u32 s67, s75
    s_cselect_b32 s79, 0xff00ff00, 0
    s_or_b32 s78, s78, s79
    s_mov_b32 vcc_lo, s78
    s_mov_b32 vcc_hi, s78
    v_cndmask_b32 v17, v25, v17, vcc
    s_cmp_lt_u32 s68, s75
    s_cselect_b32 s78, 0x00ff00ff, 0
    s_cmp_lt_u32 s69, s75
    s_cselect_b32 s79, 0xff00ff00, 0
    s_or_b32 s78, s78, s79
    s_mov_b32 vcc_lo, s78
    s_mov_b32 vcc_hi, s78
    v_cndmask_b32 v18, v25, v18, vcc
    s_cmp_lt_u32 s70, s75
    s_cselect_b32 s78, 0x00ff00ff, 0
    s_mov_b32 vcc_lo, s78
    s_mov_b32 vcc_hi, s78
    v_cndmask_b32 v19, v25, v19, vcc
    s_nop 0
    s_branch MK_31
HA_32:
    s_branch L_retA
MK_31:
    v_max3_f32 v30, v14, v15, v16
    v_max3_f32 v30, v30, v17, v18
    v_max_f32 v30, v30, v19
    v_mov_b32_dpp v19, v25 quad_perm:[0,1,2,3] row_mask:0xf bank_mask:0xc
    s_nop 0
    v_max_f32_dpp v30, v30, v30 row_ror:8 row_mask:0xf bank_mask:0xf
    v_mov_b32 v25, v30
    s_nop 1
    v_permlane32_swap_b32 v25, v30
    v_max_f32 v30, v30, v25
    v_mov_b32 v25, v30
    s_nop 1
    v_permlane16_swap_b32 v25, v30
    v_max_f32 v30, v30, v25
    v_sub_f32 v14, v14, v30
    v_sub_f32 v15, v15, v30
    v_sub_f32 v16, v16, v30
    v_sub_f32 v17, v17, v30
    v_sub_f32 v18, v18, v30
    v_sub_f32 v19, v19, v30
    v_mul_f32 v14, 0x3fb8aa3b, v14
    v_mul_f32 v15, 0x3fb8aa3b, v15
    v_mul_f32 v16, 0x3fb8aa3b, v16
    v_mul_f32 v17, 0x3fb8aa3b, v17
    v_mul_f32 v18, 0x3fb8aa3b, v18
    v_mul_f32 v19, 0x3fb8aa3b, v19
    v_exp_f32 v14, v14
    v_exp_f32 v15, v15
    v_exp_f32 v16, v16
    v_exp_f32 v17, v17
    v_exp_f32 v18, v18
    v_exp_f32 v19, v19
    s_lshl_b32 s78, s30, 3
    v_mov_b32 v29, s78
    v_add_f32 v31, v14, v15
    v_add_f32 v25, v16, v17
    v_add_f32 v26, v18, v19
    v_add_f32 v31, v31, v25
    v_add_f32 v31, v31, v26
    v_cvt_pk_bf16_f32 v14, v14, v14
    v_cvt_pk_bf16_f32 v15, v15, v15
    v_cvt_pk_bf16_f32 v16, v16, v16
    v_cvt_pk_bf16_f32 v17, v17, v17
    v_cvt_pk_bf16_f32 v18, v18, v18
    v_cvt_pk_bf16_f32 v19, v19, v19
    v_add_f32_dpp v31, v31, v31 row_ror:8 row_mask:0xf bank_mask:0xf
    v_and_b32 v56, v14, v0
    v_and_b32 v58, v15, v0
    v_and_b32 v60, v16, v0
    v_and_b32 v62, v17, v0
    v_and_b32 v64, v18, v0
    v_and_b32 v66, v19, v0
    v_pk_mul_f32 v[32:33], v[56:57], v[4:5] op_sel:[0,0] op_sel_hi:[0,1]
    v_pk_mul_f32 v[34:35], v[56:57], v[6:7] op_sel:[0,0] op_sel_hi:[0,1]
    v_pk_mul_f32 v[36:37], v[58:59], v[4:5] op_sel:[0,0] op_sel_hi:[0,1]
    v_pk_mul_f32 v[38:39], v[58:59], v[6:7] op_sel:[0,0] op_sel_hi:[0,1]
    v_pk_mul_f32 v[40:41], v[60:61], v[4:5] op_sel:[0,0] op_sel_hi:[0,1]
    v_pk_mul_f32 v[42:43], v[60:61], v[6:7] op_sel:[0,0] op_sel_hi:[0,1]
    v_pk_mul_f32 v[44:45], v[62:63], v[4:5] op_sel:[0,0] op_sel_hi:[0,1]
    v_pk_mul_f32 v[46:47], v[62:63], v[6:7] op_sel:[0,0] op_sel_hi:[0,1]
    v_pk_mul_f32 v[48:49], v[64:65], v[4:5] op_sel:[0,0] op_sel_hi:[0,1]
    v_pk_mul_f32 v[50:51], v[64:65], v[6:7] op_sel:[0,0] op_sel_hi:[0,1]
    v_pk_mul_f32 v[52:53], v[66:67], v[4:5] op_sel:[0,0] op_sel_hi:[0,1]
    v_pk_mul_f32 v[54:55], v[66:67], v[6:7] op_sel:[0,0] op_sel_hi:[0,1]
    v_mov_b32 v26, v31
    s_nop 1
    v_permlane32_swap_b32 v26, v31
    v_add_f32 v31, v31, v26
    v_mov_b32 v26, v31
    s_nop 1
    v_permlane16_swap_b32 v26, v31
    v_add_f32 v31, v31, v26
    ds_write_b64 v29, v[30:31] offset:320
    v_mov_b32 v25, 1
    s_mov_b32 exec_lo, 0x1
    s_mov_b32 exec_hi, 0x0
    ds_add_u32 v21, v25 offset:260
    s_mov_b64 exec, -1
    s_cmp_eq_u32 s76, 21
    s_cbranch_scc1 L_att_c22
    s_cmp_eq_u32 s76, 20
    s_cbranch_scc1 L_att_c21
    s_cmp_eq_u32 s76, 19
    s_cbranch_scc1 L_att_c20
    s_cmp_eq_u32 s76, 18
    s_cbranch_scc1 L_att_c19
    s_cmp_eq_u32 s76, 17
    s_cbranch_scc1 L_att_c18
    s_cmp_eq_u32 s76, 16
    s_cbranch_scc1 L_att_c17
    s_cmp_eq_u32 s76, 15
    s_cbranch_scc1 L_att_c16
    s_branch L_att_c15
HA_33:
    s_branch L_retA
L_att_c15:
    s_waitcnt vmcnt(1)
    buffer_load_dwordx4 v[92:95], v20, s[44:47], s64 offen nt
L_att_c16:
    s_waitcnt vmcnt(1)
    buffer_load_dwordx4 v[96:99], v20, s[44:47], s65 offen nt
L_att_c17:
    s_waitcnt vmcnt(1)
    buffer_load_dwordx4 v[100:103], v20, s[44:47], s66 offen nt
L_att_c18:
    s_waitcnt vmcnt(1)
    buffer_load_dwordx4 v[104:107], v20, s[44:47], s67 offen nt
L_att_c19:
    s_waitcnt vmcnt(1)
    buffer_load_dwordx4 v[108:111], v20, s[44:47], s68 offen nt
L_att_c20:
    s_waitcnt vmcnt(1)
    buffer_load_dwordx4 v[112:115], v20, s[44:47], s69 offen nt
L_att_c21:
    s_waitcnt vmcnt(1)
    buffer_load_dwordx4 v[116:119], v20, s[44:47], s70 offen nt
    s_cmp_lg_u32 s30, 1
    s_cbranch_scc1 TK_34
    s_mov_b64 exec, 1
    global_atomic_inc v22, v23, v22, s[52:53] sc0 sc1
    s_mov_b64 exec, -1
TK_34:
L_att_c22:
    s_mul_i32 s79, s30, 576
    v_lshlrev_b32 v26, 2, v1
    v_add_u32 v26, s79, v26
    v_and_b32 v28, 3, v1
    v_mul_u32_u24 v27, 576, v28
    v_bfe_u32 v28, v1, 4, 1
    v_lshl_add_u32 v27, v28, 8, v27
    v_bfe_u32 v28, v1, 5, 1
    v_lshl_add_u32 v27, v28, 6, v27
    v_bfe_u32 v28, v1, 2, 2
    v_lshl_add_u32 v27, v28, 4, v27
    s_and_b32 s79, s30, 1
    s_lshl_b32 s79, s79, 7
    v_add_u32 v27, s79, v27
    v_and_b32 v28, 60, v1
    v_lshlrev_b32 v28, 2, v28
    v_lshlrev_b32 v29, 3, v3
    s_mul_i32 s76, s100, 6
    s_add_u32 s76, s76, s101
    s_lshl_b32 s76, s76, 1
    s_and_b32 s77, s30, 1
    s_add_u32 s76, s76, s77
    s_lshl_b32 s76, s76, 8
    s_add_u32 s76, s76, 131072
    s_add_u32 s72, s76, 327680
    v_lshrrev_b32 v24, 3, v1
    v_mul_u32_u24 v20, 5120, v24
    v_and_b32 v24, 7, v1
    v_lshl_add_u32 v20, v24, 4, v20
    s_and_b32 s64, s3, 7
    s_bfe_u32 s73, s30, 0x10002
    s_lshl_b32 s68, s73, 3
    s_add_u32 s68, s68, s64
    s_and_b32 s71, s30, 3
    s_lshl_b32 s66, s68, 2
    s_add_u32 s66, s66, s71
    s_mul_i32 s60, s66, 40960
    s_cmp_ge_u32 s30, 8
    s_cselect_b32 s67, 5242880, 0
    s_mov_b32 s48, s12
    s_and_b32 s49, s13, 0xffff
    s_mov_b32 s50, s67
    s_mov_b32 s51, 0x20000
    s_lshl_b32 s69, s64, 7
    s_add_u32 s69, s69, 65536
    s_mul_i32 s70, s68, 3072
    s_lshl_b32 s71, s71, 7
    s_add_u32 s70, s70, s71
    s_add_u32 s70, s70, 131071
    s_lshl_b32 s62, s64, 14
    s_add_u32 s62, s62, 262144
    s_waitcnt vmcnt(10)
    v_mfma_f32_16x16x32_bf16 v[120:123], v[76:79], v[32:35], 0
    s_waitcnt vmcnt(9)
    v_mfma_f32_16x16x32_bf16 v[124:127], v[80:83], v[32:35], 0
    s_waitcnt vmcnt(8)
    v_mfma_f32_16x16x32_bf16 v[120:123], v[84:87], v[36:39], v[120:123]
    s_waitcnt vmcnt(7)
    v_mfma_f32_16x16x32_bf16 v[124:127], v[88:91], v[36:39], v[124:127]
    s_waitcnt vmcnt(6)
    v_mfma_f32_16x16x32_bf16 v[120:123], v[92:95], v[40:43], v[120:123]
    s_waitcnt vmcnt(5)
    v_mfma_f32_16x16x32_bf16 v[124:127], v[96:99], v[40:43], v[124:127]
    s_waitcnt vmcnt(4)
    v_mfma_f32_16x16x32_bf16 v[120:123], v[100:103], v[44:47], v[120:123]
    s_waitcnt vmcnt(3)
    v_mfma_f32_16x16x32_bf16 v[124:127], v[104:107], v[44:47], v[124:127]
    s_waitcnt vmcnt(2)
    v_mfma_f32_16x16x32_bf16 v[120:123], v[108:111], v[48:51], v[120:123]
    v_bfe_u32 v86, v3, 2, 1
    v_mul_u32_u24 v86, 3, v86
    v_lshrrev_b32 v87, 3, v3
    s_lshl_b32 s77, s73, 5
    v_lshl_add_u32 v81, v86, 2, s77
    v_lshl_add_u32 v80, v87, 2, v81
    v_and_b32 v78, 3, v3
    v_lshlrev_b32 v78, 2, v78
    v_lshrrev_b32 v79, 3, v1
    v_lshl_add_u32 v78, v79, 4, v78
    v_lshl_add_u32 v84, v86, 9, v78
    v_lshl_add_u32 v82, v87, 9, v84
    v_xor_b32 v87, 1, v87
    v_lshl_add_u32 v83, v87, 9, v84
    v_lshl_add_u32 v85, v87, 2, v81
    s_cmp_lg_u32 s30, 0
    s_cbranch_scc1 ML_35
    s_waitcnt vmcnt(0)
    v_mfma_f32_16x16x32_bf16 v[124:127], v[112:115], v[48:51], v[124:127]
    v_mfma_f32_16x16x32_bf16 v[120:123], v[116:119], v[52:55], v[120:123]
    s_lshl_b32 s77, s100, 7
    s_lshl_b32 s78, s101, 4
    s_add_u32 s77, s77, s78
    s_add_u32 s77, s77, 65536
    s_getreg_b32 s74, hwreg(HW_REG_XCC_ID, 0, 4)
    s_lshl_b32 s74, s74, 10
    s_mov_b32 s34, 0
CL_36:
    ds_read_b32 v24, v21 offset:260
    ds_read_b64 v[10:11], v29 offset:320
    s_waitcnt lgkmcnt(0)
    v_cmp_eq_u32 vcc, 16, v24
    s_nop 0
    s_cbranch_vccnz CD_37
    s_add_u32 s34, s34, 1
    s_cmp_lt_u32 s34, 480000
    s_cbranch_scc1 CL_36
    s_branch CD_37
HA_38:
    s_branch L_retA
CD_37:
    v_mov_b32 v24, v10
    s_nop 1
    v_max_f32_dpp v24, v24, v24 quad_perm:[1,0,3,2] row_mask:0xf bank_mask:0xf
    s_nop 1
    v_max_f32_dpp v24, v24, v24 quad_perm:[2,3,0,1] row_mask:0xf bank_mask:0xf
    s_nop 1
    v_max_f32_dpp v24, v24, v24 row_half_mirror row_mask:0xf bank_mask:0xf
    s_nop 1
    v_max_f32_dpp v24, v24, v24 row_mirror row_mask:0xf bank_mask:0xf
    v_sub_f32 v30, v30, v24
    v_mul_f32 v30, 0x3fb8aa3b, v30
    v_exp_f32 v30, v30
    v_sub_f32 v10, v10, v24
    v_mul_f32 v10, 0x3fb8aa3b, v10
    v_exp_f32 v10, v10
    v_or_b32 v12, s74, v9
    v_mov_b32 v13, v9
    v_mul_f32 v11, v11, v10
    v_bfi_b32 v10, s35, v9, v24
    s_nop 0
    v_add_f32_dpp v11, v11, v11 quad_perm:[1,0,3,2] row_mask:0xf bank_mask:0xf
    s_nop 1
    v_add_f32_dpp v11, v11, v11 quad_perm:[2,3,0,1] row_mask:0xf bank_mask:0xf
    s_nop 1
    v_add_f32_dpp v11, v11, v11 row_half_mirror row_mask:0xf bank_mask:0xf
    s_nop 1
    v_add_f32_dpp v11, v11, v11 row_mirror row_mask:0xf bank_mask:0xf
    v_bfi_b32 v11, s35, v9, v11
    s_mov_b32 exec_lo, 0x1
    s_mov_b32 exec_hi, 0x0
    buffer_store_dwordx4 v[10:13], v21, s[36:39], s77 offen sc1
    s_mov_b64 exec, -1
    v_add_f32_dpp v14, v124, v120 row_ror:8 row_mask:0xf bank_mask:0x3
    s_nop 1
    v_add_f32_dpp v14, v121, v125 row_ror:8 row_mask:0xf bank_mask:0xc
    v_add_f32_dpp v15, v126, v122 row_ror:8 row_mask:0xf bank_mask:0x3
    s_nop 1
    v_add_f32_dpp v15, v123, v127 row_ror:8 row_mask:0xf bank_mask:0xc
    v_mul_f32 v14, v14, v30
    v_mul_f32 v15, v15, v30
    ds_write_b32 v26, v14 offset:1024
    ds_write_b32 v26, v15 offset:1280
    v_and_b32 v24, 7, v1
    v_cmp_gt_u32 vcc, 6, v24
    s_nop 1
    v_cndmask_b32 v89, 0, 1.0, vcc
    v_min_u32 v24, 5, v24
    v_lshlrev_b32 v24, 4, v24
    v_bfe_u32 v25, v1, 3, 1
    v_add_u32 v25, s73, v25
    s_lshl_b32 s77, s73, 5
    v_lshl_add_u32 v90, v3, 2, s77
    v_lshl_add_u32 v88, v25, 10, v24
    s_setprio 3
    s_waitcnt lgkmcnt(0)
    s_barrier
    ds_read_b32 v24, v21 offset:664
    s_waitcnt lgkmcnt(0)
    v_readfirstlane_b32 s65, v24
    s_cmp_ge_u32 s65, 20
    s_nop 2
    s_cbranch_scc1 L_end
    s_cmp_ge_u32 s65, 10
    s_cselect_b32 s65, 2048, 0
    s_cselect_b32 s66, 49153, 1
    s_add_u32 s69, s69, s65
    buffer_load_dwordx4 v[76:79], v88, s[36:39], s69 offen sc1
    s_barrier
    s_waitcnt vmcnt(0)
    v_xor_b32 v76, v76, v9
    v_xor_b32 v77, v77, v9
    v_xor_b32 v78, v78, v9
    v_xor_b32 v79, v79, v9
    v_or3_b32 v24, v76, v77, v78
    v_or_b32 v24, v24, v79
    v_and_b32 v24, 0x3ff, v24
    v_cmp_ne_u32 vcc, 0, v24
    s_nop 0
    s_cbranch_vccz L_w_c
    s_mov_b32 s34, 0
PM_39:
    buffer_load_dwordx4 v[76:79], v88, s[36:39], s69 offen sc1
    s_waitcnt vmcnt(0)
    v_xor_b32 v76, v76, v9
    v_xor_b32 v77, v77, v9
    v_xor_b32 v78, v78, v9
    v_xor_b32 v79, v79, v9
    v_or3_b32 v24, v76, v77, v78
    v_or_b32 v24, v24, v79
    v_and_b32 v24, 0x3ff, v24
    v_cmp_ne_u32 vcc, 0, v24
    s_nop 0
    s_cbranch_vccz PMd_40
    s_add_u32 s34, s34, 1
    s_cmp_lt_u32 s34, 30000
    s_cbranch_scc1 PM_39
PMd_40:
L_w_c:
    v_max_f32_dpp v24, v76, v76 quad_perm:[1,0,3,2] row_mask:0xf bank_mask:0xf
    v_cmp_ne_u32 vcc, s74, v78
    s_nop 0
    v_max_f32_dpp v24, v24, v24 quad_perm:[2,3,0,1] row_mask:0xf bank_mask:0xf
    s_nop 1
    v_max_f32_dpp v24, v24, v24 row_half_mirror row_mask:0xf bank_mask:0xf
    v_mul_f32 v77, v77, v89
    v_sub_f32 v76, v76, v24
    v_mul_f32 v76, 0x3fb8aa3b, v76
    v_exp_f32 v76, v76
    s_cmp_eq_u64 vcc, 0
    s_cselect_b32 s77, 327680, 0
    s_add_u32 s77, s77, s66
    v_mov_b32 v25, s77
    v_mul_f32 v24, v76, v77
    s_nop 1
    v_add_f32_dpp v24, v24, v24 quad_perm:[1,0,3,2] row_mask:0xf bank_mask:0xf
    s_nop 1
    v_add_f32_dpp v24, v24, v24 quad_perm:[2,3,0,1] row_mask:0xf bank_mask:0xf
    s_nop 1
    v_add_f32_dpp v24, v24, v24 row_half_mirror row_mask:0xf bank_mask:0xf
    v_rcp_f32 v24, v24
    s_nop 0
    v_mul_f32 v76, v76, v24
    ds_write_b32 v90, v76 offset:512
    ds_write_b32 v21, v25 offset:640
    s_waitcnt lgkmcnt(0)
    s_endpgm
HA_41:
    s_branch L_retA
ML_35:
    s_cmp_lg_u32 s30, 1
    s_cbranch_scc1 TW_42
    s_waitcnt vmcnt(0)
    v_readfirstlane_b32 s65, v22
    s_cmp_ge_u32 s65, 10
    s_cselect_b32 s66, 2620160, 0
    s_lshl_b32 s77, s65, 7
    s_add_u32 s66, s66, s77
    s_lshl_b32 s77, s65, 8
    s_cmp_ge_u32 s65, 20
    s_cselect_b32 s66, 0x40000000, s66
    v_mov_b32 v76, s66
    v_mov_b32 v77, s77
    v_mov_b32 v78, s65
    ds_write_b96 v21, v[76:78] offset:656
    s_waitcnt lgkmcnt(0)
TW_42:
    s_barrier
    ds_read_b64 v[10:11], v29 offset:320
    s_cmp_lt_u32 s30, 8
    s_cbranch_scc1 WS_43
    ds_read_b96 v[76:78], v21 offset:656
    s_waitcnt lgkmcnt(0)
    v_readfirstlane_b32 s65, v78
    v_add_u32 v20, v20, v76
    s_cmp_ge_u32 s65, 20
    s_nop 1
    s_cbranch_scc1 WS_43
    buffer_load_dwordx4 v[56:59], v20, s[48:51], s60 offen offset:0 nt
    buffer_load_dwordx4 v[60:63], v20, s[48:51], s60 offen offset:1280 nt
    buffer_load_dwordx4 v[64:67], v20, s[48:51], s60 offen offset:2560 nt
    buffer_load_dwordx4 v[68:71], v20, s[48:51], s60 offen offset:3840 nt
    v_readfirstlane_b32 s63, v77
    s_add_u32 s62, s62, s63
    v_mov_b32 v24, v10
    s_nop 1
    v_max_f32_dpp v24, v24, v24 quad_perm:[1,0,3,2] row_mask:0xf bank_mask:0xf
    s_nop 1
    v_max_f32_dpp v24, v24, v24 quad_perm:[2,3,0,1] row_mask:0xf bank_mask:0xf
    s_nop 1
    v_max_f32_dpp v24, v24, v24 row_half_mirror row_mask:0xf bank_mask:0xf
    s_nop 1
    v_max_f32_dpp v24, v24, v24 row_mirror row_mask:0xf bank_mask:0xf
    v_sub_f32 v30, v30, v24
    v_mul_f32 v30, 0x3fb8aa3b, v30
    v_exp_f32 v30, v30
    s_nop 0
    s_branch WJ_44
WS_43:
    s_waitcnt lgkmcnt(0)
    v_mov_b32 v24, v10
    s_nop 1
    v_max_f32_dpp v24, v24, v24 quad_perm:[1,0,3,2] row_mask:0xf bank_mask:0xf
    s_nop 1
    v_max_f32_dpp v24, v24, v24 quad_perm:[2,3,0,1] row_mask:0xf bank_mask:0xf
    s_nop 1
    v_max_f32_dpp v24, v24, v24 row_half_mirror row_mask:0xf bank_mask:0xf
    s_nop 1
    v_max_f32_dpp v24, v24, v24 row_mirror row_mask:0xf bank_mask:0xf
    v_sub_f32 v30, v30, v24
    v_mul_f32 v30, 0x3fb8aa3b, v30
    v_exp_f32 v30, v30
    s_waitcnt vmcnt(0)
WJ_44:
    s_waitcnt vmcnt(5)
    v_mfma_f32_16x16x32_bf16 v[124:127], v[112:115], v[48:51], v[124:127]
    s_waitcnt vmcnt(4)
    v_mfma_f32_16x16x32_bf16 v[120:123], v[116:119], v[52:55], v[120:123]
    s_nop 7
    v_add_f32_dpp v14, v124, v120 row_ror:8 row_mask:0xf bank_mask:0x3
    s_nop 1
    v_add_f32_dpp v14, v121, v125 row_ror:8 row_mask:0xf bank_mask:0xc
    v_add_f32_dpp v15, v126, v122 row_ror:8 row_mask:0xf bank_mask:0x3
    s_nop 1
    v_add_f32_dpp v15, v123, v127 row_ror:8 row_mask:0xf bank_mask:0xc
    v_mul_f32 v14, v14, v30
    v_mul_f32 v15, v15, v30
    ds_write_b32 v26, v14 offset:1024
    ds_write_b32 v26, v15 offset:1280
L_att_fin:
    s_waitcnt lgkmcnt(0)
    s_barrier
    s_cmp_ge_u32 s30, 8
    s_cbranch_scc1 L_w
    s_lshr_b32 s77, s30, 1
    s_cmp_lg_u32 s77, 1
    s_cbranch_scc1 L_end
    s_setprio 3
    ds_read_b128 v[32:35], v27 offset:1024
    ds_read_b128 v[36:39], v27 offset:3328
    ds_read_b128 v[40:43], v27 offset:5632
    ds_read_b128 v[44:47], v27 offset:7936
    s_waitcnt lgkmcnt(2)
    v_add_f32 v32, v32, v36
    v_add_f32 v33, v33, v37
    v_add_f32 v34, v34, v38
    v_add_f32 v35, v35, v39
    s_waitcnt lgkmcnt(0)
    v_add_f32 v40, v40, v44
    v_add_f32 v41, v41, v45
    v_add_f32 v42, v42, v46
    v_add_f32 v43, v43, v47
    v_add_f32 v32, v32, v40
    v_add_f32 v33, v33, v41
    v_add_f32 v34, v34, v42
    v_add_f32 v35, v35, v43
    v_add_f32_dpp v32, v32, v32 quad_perm:[1,0,3,2] row_mask:0xf bank_mask:0xf
    v_add_f32_dpp v33, v33, v33 quad_perm:[1,0,3,2] row_mask:0xf bank_mask:0xf
    v_add_f32_dpp v34, v34, v34 quad_perm:[1,0,3,2] row_mask:0xf bank_mask:0xf
    v_add_f32_dpp v35, v35, v35 quad_perm:[1,0,3,2] row_mask:0xf bank_mask:0xf
    v_add_f32_dpp v32, v32, v32 quad_perm:[2,3,0,1] row_mask:0xf bank_mask:0xf
    v_add_f32_dpp v33, v33, v33 quad_perm:[2,3,0,1] row_mask:0xf bank_mask:0xf
    v_add_f32_dpp v34, v34, v34 quad_perm:[2,3,0,1] row_mask:0xf bank_mask:0xf
    v_add_f32_dpp v35, v35, v35 quad_perm:[2,3,0,1] row_mask:0xf bank_mask:0xf
    v_bfi_b32 v32, s35, v9, v32
    v_bfi_b32 v33, s35, v9, v33
    v_bfi_b32 v34, s35, v9, v34
    v_bfi_b32 v35, s35, v9, v35
    s_mov_b32 exec_lo, 0x11111111
    s_mov_b32 exec_hi, 0x11111111
    buffer_store_dwordx4 v[32:35], v28, s[36:39], s72 offen
    buffer_store_dwordx4 v[32:35], v28, s[36:39], s76 offen sc1
    s_mov_b64 exec, -1
    s_endpgm
L_w:
    s_cmp_ge_u32 s65, 20
    s_cbranch_scc1 L_end
    s_mov_b32 s34, 0
L_w_sp:
    ds_read_b32 v24, v21 offset:640
    s_add_u32 s34, s34, 1
    s_cmp_ge_u32 s34, 1920000
    s_cbranch_scc1 L_end
    s_waitcnt lgkmcnt(0)
    v_cmp_eq_u32 vcc, 0, v24
    s_nop 0
    s_cbranch_vccnz L_w_sp
    ds_read_b32 v10, v80 offset:512
    ds_read_b32 v11, v85 offset:512
    ds_read_b32 v12, v81 offset:520
    v_readfirstlane_b32 s77, v24
    s_add_u32 s70, s70, s77
    buffer_load_dword v88, v82, s[36:39], s70 offen offset:0 sc1
    buffer_load_dword v89, v83, s[36:39], s70 offen offset:0 sc1
    buffer_load_dword v90, v84, s[36:39], s70 offen offset:1024 sc1
    v_and_b32 v25, 1, v1
    v_lshl_add_u32 v28, v25, 13, v28
    v_and_b32 v25, 60, v1
    v_bfe_u32 v27, v25, 4, 1
    v_lshlrev_b32 v27, 6, v27
    v_bfe_u32 v24, v25, 5, 1
    v_lshl_add_u32 v27, v24, 4, v27
    v_bfe_u32 v24, v25, 3, 1
    v_lshl_add_u32 v27, v24, 5, v27
    v_and_b32 v24, 7, v25
    v_add_u32 v27, v27, v24
    v_lshlrev_b32 v27, 2, v27
    v_and_b32 v24, 3, v1
    v_mul_u32_u24 v24, 576, v24
    v_add_u32 v27, v27, v24
    s_waitcnt vmcnt(0) lgkmcnt(0)
    v_xor_b32 v88, v88, v9
    v_xor_b32 v89, v89, v9
    v_xor_b32 v90, v90, v9
    v_or3_b32 v25, v88, v89, v90
    v_and_b32 v25, 0x3ff, v25
    v_cmp_ne_u32 vcc, 0, v25
    s_nop 0
    s_cbranch_vccz L_w_go
    s_mov_b32 s34, 0
PO_45:
    buffer_load_dword v88, v82, s[36:39], s70 offen offset:0 sc1
    buffer_load_dword v89, v83, s[36:39], s70 offen offset:0 sc1
    s_branch BA_63x
    .p2alignl 12, 0xbf810000
BA_63:
    s_branch L_retA
BA_63x:
    buffer_load_dword v90, v84, s[36:39], s70 offen offset:1024 sc1
    s_waitcnt vmcnt(0)
    v_xor_b32 v88, v88, v9
    v_xor_b32 v89, v89, v9
    v_xor_b32 v90, v90, v9
    v_or3_b32 v25, v88, v89, v90
    v_and_b32 v25, 0x3ff, v25
    v_cmp_ne_u32 vcc, 0, v25
    s_nop 0
    s_cbranch_vccz POd_46
    s_add_u32 s34, s34, 1
    s_cmp_lt_u32 s34, 30000
    s_cbranch_scc1 PO_45
    s_branch POd_46
HA_47:
    s_branch L_retA
POd_46:
L_w_go:
    v_mul_f32 v14, v10, v88
    v_fmac_f32 v14, v11, v89
    v_fmac_f32 v14, v12, v90
    s_nop 1
    v_add_f32_dpp v14, v14, v14 row_shl:4 row_mask:0xf bank_mask:0x5
    v_cvt_pk_bf16_f32 v14, v14, v14
    s_nop 1
    v_and_b32_dpp v16, v14, v0 row_newbcast:0 row_mask:0xf bank_mask:0x3
    s_nop 1
    v_and_b32_dpp v16, v14, v0 row_newbcast:8 row_mask:0xf bank_mask:0xc
    v_pk_mul_f32 v[92:93], v[16:17], v[4:5] op_sel:[0,0] op_sel_hi:[0,1]
    v_pk_mul_f32 v[94:95], v[16:17], v[6:7] op_sel:[0,0] op_sel_hi:[0,1]
    v_and_b32_dpp v18, v14, v0 row_newbcast:1 row_mask:0xf bank_mask:0x3
    s_nop 1
    v_and_b32_dpp v18, v14, v0 row_newbcast:9 row_mask:0xf bank_mask:0xc
    v_pk_mul_f32 v[96:97], v[18:19], v[4:5] op_sel:[0,0] op_sel_hi:[0,1]
    v_pk_mul_f32 v[98:99], v[18:19], v[6:7] op_sel:[0,0] op_sel_hi:[0,1]
    v_mfma_f32_16x16x32_bf16 v[120:123], v[56:59], v[92:95], 0
    v_and_b32_dpp v16, v14, v0 row_newbcast:2 row_mask:0xf bank_mask:0x3
    s_nop 1
    v_and_b32_dpp v16, v14, v0 row_newbcast:10 row_mask:0xf bank_mask:0xc
    v_pk_mul_f32 v[92:93], v[16:17], v[4:5] op_sel:[0,0] op_sel_hi:[0,1]
    v_pk_mul_f32 v[94:95], v[16:17], v[6:7] op_sel:[0,0] op_sel_hi:[0,1]
    v_mfma_f32_16x16x32_bf16 v[120:123], v[60:63], v[96:99], v[120:123]
    v_and_b32_dpp v18, v14, v0 row_newbcast:3 row_mask:0xf bank_mask:0x3
    s_nop 1
    v_and_b32_dpp v18, v14, v0 row_newbcast:11 row_mask:0xf bank_mask:0xc
    v_pk_mul_f32 v[96:97], v[18:19], v[4:5] op_sel:[0,0] op_sel_hi:[0,1]
    v_pk_mul_f32 v[98:99], v[18:19], v[6:7] op_sel:[0,0] op_sel_hi:[0,1]
    v_mfma_f32_16x16x32_bf16 v[120:123], v[64:67], v[92:95], v[120:123]
    s_nop 0
    v_mfma_f32_16x16x32_bf16 v[120:123], v[68:71], v[96:99], v[120:123]
    s_nop 7
    v_permlane32_swap_b32 v120, v121
    v_permlane32_swap_b32 v122, v123
    s_nop 0
    v_add_f32_dpp v22, v121, v120 row_ror:8 row_mask:0xf bank_mask:0x3
    v_add_f32_dpp v23, v123, v122 row_ror:8 row_mask:0xf bank_mask:0x3
    ds_write_b32 v26, v22 offset:10240
    ds_write_b32 v26, v23 offset:10496
    s_waitcnt lgkmcnt(0)
    s_barrier
    s_cmp_lg_u32 s30, 8
    s_cbranch_scc1 L_end
    ds_read_b128 v[32:35], v27 offset:14848
    ds_read_b128 v[36:39], v27 offset:17152
    s_waitcnt lgkmcnt(0)
    v_add_f32 v32, v32, v36
    v_add_f32 v33, v33, v37
    v_add_f32 v34, v34, v38
    v_add_f32 v35, v35, v39
    v_add_f32_dpp v32, v32, v32 quad_perm:[1,0,3,2] row_mask:0xf bank_mask:0xf
    v_add_f32_dpp v33, v33, v33 quad_perm:[1,0,3,2] row_mask:0xf bank_mask:0xf
    v_add_f32_dpp v34, v34, v34 quad_perm:[1,0,3,2] row_mask:0xf bank_mask:0xf
    v_add_f32_dpp v35, v35, v35 quad_perm:[1,0,3,2] row_mask:0xf bank_mask:0xf
    v_add_f32_dpp v32, v32, v32 quad_perm:[2,3,0,1] row_mask:0xf bank_mask:0xf
    v_add_f32_dpp v33, v33, v33 quad_perm:[2,3,0,1] row_mask:0xf bank_mask:0xf
    v_add_f32_dpp v34, v34, v34 quad_perm:[2,3,0,1] row_mask:0xf bank_mask:0xf
    v_add_f32_dpp v35, v35, v35 quad_perm:[2,3,0,1] row_mask:0xf bank_mask:0xf
    v_bfi_b32 v32, s35, v9, v32
    s_mov_b32 exec_lo, 0x33333333
    s_mov_b32 exec_hi, 0x33333333
    buffer_store_dwordx4 v[32:35], v28, s[36:39], s62 offen sc1
    s_mov_b64 exec, -1
    s_endpgm
HF_48:
    s_branch L_retF
L_f:
    s_sub_u32 s69, s2, 37
    v_and_b32 v32, 3, v3
    v_mul_u32_u24 v13, 0x5555, v32
    v_and_b32 v32, 1, v2
    v_lshrrev_b32 v33, 1, v2
    v_lshl_add_u32 v33, v32, 3, v33
    v_mov_b32 v48, 0
    v_mov_b32 v49, 0
    v_mov_b32 v50, 0
    v_mov_b32 v51, 0
    v_mov_b32 v52, 0
    v_mov_b32 v53, 0
    v_mov_b32 v54, 0
    v_mov_b32 v55, 0
    s_cmp_ge_u32 s30, 10
    s_cbranch_scc1 L_fd
    s_lshl_b32 s73, s30, 6
    v_lshl_add_u32 v10, v3, 2, v2
    v_add_u32 v10, s73, v10
    v_lshlrev_b32 v32, 1, v10
    v_lshlrev_b32 v10, 2, v10
    buffer_load_ushort v44, v32, s[52:55], 0 offen
    v_lshl_add_u64 v[56:57], v[56:57], 0, s[64:65]
    s_waitcnt vmcnt(3)
    global_load_dwordx4 v[104:107], v[56:57], off offset:-3456 nt
    s_waitcnt vmcnt(3)
    global_load_dwordx4 v[108:111], v[56:57], off offset:3456 nt
    v_lshl_add_u64 v[56:57], v[56:57], 0, s[66:67]
    s_waitcnt vmcnt(3)
    global_load_dwordx4 v[112:115], v[56:57], off offset:-3456 nt
    s_waitcnt vmcnt(3)
    global_load_dwordx4 v[116:119], v[56:57], off offset:3456 nt
    v_lshl_add_u64 v[56:57], v[56:57], 0, s[64:65]
    s_waitcnt vmcnt(3)
    global_load_dwordx4 v[120:123], v[56:57], off offset:-3456 nt
    s_waitcnt vmcnt(3)
    global_load_dwordx4 v[124:127], v[56:57], off offset:3456 nt
    s_mov_b32 s62, -179712
    s_mov_b32 s63, -1
    v_lshl_add_u64 v[56:57], v[56:57], 0, s[62:63]
    s_waitcnt vmcnt(3)
    global_load_dwordx4 v[64:67], v[56:57], off offset:-3456 nt
    s_waitcnt vmcnt(3)
    global_load_dwordx4 v[68:71], v[56:57], off offset:3456 nt
    v_lshl_add_u64 v[56:57], v[56:57], 0, s[64:65]
    s_waitcnt vmcnt(3)
    global_load_dwordx4 v[72:75], v[56:57], off offset:-3456 nt
    s_waitcnt vmcnt(3)
    global_load_dwordx4 v[76:79], v[56:57], off offset:3456 nt
    v_lshl_add_u64 v[56:57], v[56:57], 0, s[66:67]
    s_waitcnt vmcnt(3)
    global_load_dwordx4 v[80:83], v[56:57], off offset:-3456 nt
    s_waitcnt vmcnt(3)
    global_load_dwordx4 v[84:87], v[56:57], off offset:3456 nt
    v_lshl_add_u64 v[56:57], v[56:57], 0, s[64:65]
    s_waitcnt vmcnt(3)
    global_load_dwordx4 v[88:91], v[56:57], off offset:-3456 nt
    s_waitcnt vmcnt(3)
    global_load_dwordx4 v[92:95], v[56:57], off offset:3456 nt
    s_barrier
    v_lshlrev_b32 v60, 2, v1
    s_lshl_b32 s79, s30, 9
    v_lshl_add_u32 v45, v3, 5, s79
    v_lshrrev_b32 v32, 1, v2
    v_mul_u32_u24 v11, 9216, v32
    v_add_u32 v11, v11, v45
    v_and_b32 v33, 1, v2
    v_mul_u32_u24 v58, 2560, v33
    v_lshl_add_u32 v58, v32, 14, v58
    v_lshl_add_u32 v58, v3, 4, v58
    s_lshl_b32 s73, s30, 3
    v_lshrrev_b32 v59, 3, v1
    v_add_u32 v59, s73, v59
    s_mov_b32 s63, 9216
    s_mov_b32 s64, 14336
    s_mov_b32 s75, 20480
    buffer_load_dword v40, v60, s[36:39], s75 offen sc1
    s_mov_b32 s34, 0
PG_49:
    buffer_load_dword v37, v10, s[36:39], s63 offen sc1
    buffer_load_dword v38, v10, s[36:39], s63 offen offset:2560 sc1
    buffer_load_dword v39, v10, s[36:39], s64 offen sc1
    s_waitcnt vmcnt(0)
    v_xor_b32 v37, v37, v8
    v_xor_b32 v38, v38, v8
    v_xor_b32 v39, v39, v8
    v_or3_b32 v32, v37, v38, v39
    v_and_b32 v32, 0xffff, v32
    v_cmp_ne_u32 vcc, 0, v32
    s_nop 0
    s_cbranch_vccz PGd_50
    s_add_u32 s34, s34, 1
    s_cmp_lt_u32 s34, 30000
    s_cbranch_scc1 PG_49
    s_branch PGd_50
HF_51:
    s_branch L_retF
PGd_50:
    s_lshl_b32 s76, s31, 2
    s_or_b32 s77, s76, 1
    s_or_b32 s76, s76, 2
    v_cmp_eq_u32 vcc, s77, v40
    s_bcnt1_i32_b64 s77, vcc
    v_cmp_eq_u32 vcc, s76, v40
    s_bcnt1_i32_b64 s76, vcc
    s_cmp_gt_u32 s76, s77
    s_cselect_b32 s77, 1, 0
    s_getreg_b32 s76, hwreg(HW_REG_XCC_ID, 2, 1)
    s_xor_b32 s76, s76, s77
    s_lshl_b32 s70, s76, 13
    s_lshl_b32 s73, s30, 8
    s_add_u32 s70, s70, s73
    s_add_u32 s65, s70, 262144
    s_add_u32 s66, s70, 294912
    s_add_u32 s67, s70, 327680
    s_add_u32 s68, s70, 360448
    v_add_f32 v39, 1.0, v39
    v_cvt_pk_bf16_f32 v39, 0, v39
    v_lshlrev_b32 v44, 16, v44
    v_swap_b32 v66, v72
    v_swap_b32 v67, v73
    v_swap_b32 v70, v76
    v_swap_b32 v71, v77
    v_swap_b32 v82, v88
    v_swap_b32 v83, v89
    v_swap_b32 v86, v92
    v_swap_b32 v87, v93
    v_swap_b32 v98, v104
    v_swap_b32 v99, v105
    v_swap_b32 v102, v108
    v_swap_b32 v103, v109
    v_swap_b32 v114, v120
    v_swap_b32 v115, v121
    v_swap_b32 v118, v124
    v_swap_b32 v119, v125
    v_mov_b32_dpp v14, v39 row_newbcast:0 row_mask:0xf bank_mask:0x3
    v_mov_b32_dpp v15, v39 row_newbcast:1 row_mask:0xf bank_mask:0x3
    v_mov_b32_dpp v16, v39 row_newbcast:2 row_mask:0xf bank_mask:0x3
    v_mov_b32_dpp v17, v39 row_newbcast:3 row_mask:0xf bank_mask:0x3
    v_mov_b32_dpp v14, v38 row_newbcast:0 row_mask:0xf bank_mask:0xc
    v_mov_b32_dpp v15, v38 row_newbcast:1 row_mask:0xf bank_mask:0xc
    v_mov_b32_dpp v16, v38 row_newbcast:2 row_mask:0xf bank_mask:0xc
    v_mov_b32_dpp v17, v38 row_newbcast:3 row_mask:0xf bank_mask:0xc
    v_mov_b32_dpp v18, v39 row_newbcast:4 row_mask:0xf bank_mask:0x3
    v_mov_b32_dpp v19, v39 row_newbcast:5 row_mask:0xf bank_mask:0x3
    s_nop 0
    v_mov_b32_dpp v18, v38 row_newbcast:4 row_mask:0xf bank_mask:0xc
    v_mov_b32_dpp v19, v38 row_newbcast:5 row_mask:0xf bank_mask:0xc
    v_smfmac_f32_16x16x64_bf16 v[48:51], v[14:17], v[64:71], v13
    v_mov_b32_dpp v20, v39 row_newbcast:6 row_mask:0xf bank_mask:0x3
    v_mov_b32_dpp v21, v39 row_newbcast:7 row_mask:0xf bank_mask:0x3
    s_nop 0
    v_mov_b32_dpp v20, v38 row_newbcast:6 row_mask:0xf bank_mask:0xc
    v_mov_b32_dpp v21, v38 row_newbcast:7 row_mask:0xf bank_mask:0xc
    v_smfmac_f32_16x16x64_bf16 v[52:55], v[14:17], v[72:79], v13
    v_mov_b32_dpp v22, v39 row_newbcast:8 row_mask:0xf bank_mask:0x3
    v_mov_b32_dpp v23, v39 row_newbcast:9 row_mask:0xf bank_mask:0x3
    s_nop 0
    v_mov_b32_dpp v22, v38 row_newbcast:8 row_mask:0xf bank_mask:0xc
    v_mov_b32_dpp v23, v38 row_newbcast:9 row_mask:0xf bank_mask:0xc
    v_smfmac_f32_16x16x64_bf16 v[48:51], v[18:21], v[80:87], v13
    v_mov_b32_dpp v24, v39 row_newbcast:10 row_mask:0xf bank_mask:0x3
    v_mov_b32_dpp v25, v39 row_newbcast:11 row_mask:0xf bank_mask:0x3
    s_nop 0
    v_mov_b32_dpp v24, v38 row_newbcast:10 row_mask:0xf bank_mask:0xc
    v_mov_b32_dpp v25, v38 row_newbcast:11 row_mask:0xf bank_mask:0xc
    v_smfmac_f32_16x16x64_bf16 v[52:55], v[18:21], v[88:95], v13
    v_mov_b32_dpp v26, v39 row_newbcast:12 row_mask:0xf bank_mask:0x3
    v_mov_b32_dpp v27, v39 row_newbcast:13 row_mask:0xf bank_mask:0x3
    s_nop 0
    v_mov_b32_dpp v26, v38 row_newbcast:12 row_mask:0xf bank_mask:0xc
    v_mov_b32_dpp v27, v38 row_newbcast:13 row_mask:0xf bank_mask:0xc
    v_smfmac_f32_16x16x64_bf16 v[48:51], v[22:25], v[96:103], v13
    v_mov_b32_dpp v28, v39 row_newbcast:14 row_mask:0xf bank_mask:0x3
    v_mov_b32_dpp v29, v39 row_newbcast:15 row_mask:0xf bank_mask:0x3
    s_nop 0
    v_mov_b32_dpp v28, v38 row_newbcast:14 row_mask:0xf bank_mask:0xc
    v_mov_b32_dpp v29, v38 row_newbcast:15 row_mask:0xf bank_mask:0xc
    v_smfmac_f32_16x16x64_bf16 v[52:55], v[22:25], v[104:111], v13
    s_nop 0
    v_smfmac_f32_16x16x64_bf16 v[48:51], v[26:29], v[112:119], v13
    v_smfmac_f32_16x16x64_bf16 v[52:55], v[26:29], v[120:127], v13
    v_mov_b32 v32, 0
    v_mov_b32 v33, 1
    s_mov_b32 exec_lo, 0xffff
    s_mov_b32 exec_hi, 0xffff
    s_nop 2
    ds_write_b128 v11, v[48:51] offset:10240
    ds_write_b128 v11, v[52:55] offset:10256
    s_mov_b64 exec, -1
    s_waitcnt lgkmcnt(0)
    v_mov_b32 v48, 0
    v_mov_b32 v49, 0
    v_mov_b32 v50, 0
    v_mov_b32 v51, 0
    v_mov_b32 v52, 0
    v_mov_b32 v53, 0
    v_mov_b32 v54, 0
    v_mov_b32 v55, 0
    s_barrier
    s_mov_b32 s34, 0
    s_mov_b64 s[60:61], -1
    s_mov_b64 s[62:63], -1
    s_mov_b64 s[72:73], -1
    s_mov_b64 s[78:79], -1
PA_52:
    s_cmp_eq_u64 s[60:61], 0
    s_cbranch_scc1 SK_54
    buffer_load_dwordx4 v[14:17], v58, s[36:39], s65 offen sc1
SK_54:
    s_cmp_eq_u64 s[62:63], 0
    s_cbranch_scc1 SK_55
    buffer_load_dwordx4 v[18:21], v58, s[36:39], s66 offen sc1
SK_55:
    s_cmp_eq_u64 s[72:73], 0
    s_cbranch_scc1 SK_56
    buffer_load_dwordx4 v[22:25], v58, s[36:39], s67 offen sc1
SK_56:
    s_cmp_eq_u64 s[78:79], 0
    s_cbranch_scc1 SK_57
    buffer_load_dwordx4 v[26:29], v58, s[36:39], s68 offen sc1
SK_57:
    s_waitcnt vmcnt(0)
    v_and_b32 v32, s35, v14
    v_and_b32 v33, s35, v18
    v_and_b32 v34, s35, v22
    v_and_b32 v35, s35, v26
    v_cmp_ne_u32 s[60:61], v32, v9
    v_cmp_ne_u32 s[62:63], v33, v9
    v_cmp_ne_u32 s[72:73], v34, v9
    v_cmp_ne_u32 s[78:79], v35, v9
    s_or_b64 vcc, s[60:61], s[62:63]
    s_or_b64 vcc, vcc, s[72:73]
    s_or_b64 vcc, vcc, s[78:79]
    s_nop 0
    s_cbranch_scc0 PAd_53
    s_add_u32 s34, s34, 1
    s_cmp_lt_u32 s34, 30000
    s_cbranch_scc1 PA_52
    s_branch PAd_53
HF_58:
    s_branch L_retF
PAd_53:
    v_xor_b32 v14, v14, v9
    v_xor_b32 v18, v18, v9
    v_xor_b32 v22, v22, v9
    v_xor_b32 v26, v26, v9
    v_add_f32 v14, v14, v22
    v_add_f32 v15, v15, v23
    v_add_f32 v16, v16, v24
    v_add_f32 v17, v17, v25
    v_add_f32 v18, v18, v26
    v_add_f32 v19, v19, v27
    v_add_f32 v20, v20, v28
    v_add_f32 v21, v21, v29
    v_add_f32 v14, v14, v18
    v_add_f32 v16, v16, v20
    v_add_f32 v15, v15, v19
    v_add_f32 v17, v17, v21
    v_permlane32_swap_b32 v14, v16
    s_nop 0
    v_permlane32_swap_b32 v15, v17
    v_add_f32 v14, v14, v16
    v_add_f32 v15, v15, v17
    s_nop 1
    v_permlane16_swap_b32 v14, v15
    v_add_f32 v40, v14, v15
    v_cvt_pk_bf16_f32 v40, 0, v40
    v_mul_f32 v40, v37, v40
    v_cvt_pk_bf16_f32 v40, 0, v40
    v_add_f32 v40, v44, v40
    v_cvt_pk_bf16_f32 v40, 0, v40
    v_subrev_f32 v32, s100, v40
    v_mul_f32 v62, v32, v39
    v_cvt_pk_bf16_f32 v62, 0, v62
    v_mul_f32 v33, v32, v32
    s_nop 0
    v_mov_b32_dpp v63, v62 quad_perm:[1,1,3,3] row_mask:0xf bank_mask:0xf
    v_permlane32_swap_b32 v32, v33
    v_add_f32 v32, v32, v33
    v_mov_b64_dpp v[14:15], v[62:63] row_newbcast:0 row_mask:0xf bank_mask:0xf
    v_mov_b64_dpp v[16:17], v[62:63] row_newbcast:2 row_mask:0xf bank_mask:0xf
    v_mov_b64_dpp v[18:19], v[62:63] row_newbcast:4 row_mask:0xf bank_mask:0xf
    v_add_f32_dpp v32, v32, v32 quad_perm:[1,0,3,2] row_mask:0xf bank_mask:0xf
    v_smfmac_f32_16x16x64_bf16 v[48:51], v[14:17], v[64:71], v13
    v_mov_b64_dpp v[20:21], v[62:63] row_newbcast:6 row_mask:0xf bank_mask:0xf
    v_add_f32_dpp v32, v32, v32 quad_perm:[2,3,0,1] row_mask:0xf bank_mask:0xf
    v_smfmac_f32_16x16x64_bf16 v[52:55], v[14:17], v[72:79], v13
    v_mov_b64_dpp v[22:23], v[62:63] row_newbcast:8 row_mask:0xf bank_mask:0xf
    v_add_f32_dpp v32, v32, v32 row_half_mirror row_mask:0xf bank_mask:0xf
    v_smfmac_f32_16x16x64_bf16 v[48:51], v[18:21], v[80:87], v13
    v_mov_b64_dpp v[24:25], v[62:63] row_newbcast:10 row_mask:0xf bank_mask:0xf
    v_add_f32_dpp v32, v32, v32 row_mirror row_mask:0xf bank_mask:0xf
    v_smfmac_f32_16x16x64_bf16 v[52:55], v[18:21], v[88:95], v13
    v_mov_b64_dpp v[26:27], v[62:63] row_newbcast:12 row_mask:0xf bank_mask:0xf
    v_mov_b32 v33, v32
    v_smfmac_f32_16x16x64_bf16 v[48:51], v[22:25], v[96:103], v13
    v_mov_b64_dpp v[28:29], v[62:63] row_newbcast:14 row_mask:0xf bank_mask:0xf
    s_mov_b32 s76, 1
    v_smfmac_f32_16x16x64_bf16 v[52:55], v[22:25], v[104:111], v13
    v_permlane16_swap_b32 v33, v32
    s_mov_b32 s77, 1
    v_smfmac_f32_16x16x64_bf16 v[48:51], v[26:29], v[112:119], v13
    v_add_f32 v32, v32, v33
    v_smfmac_f32_16x16x64_bf16 v[52:55], v[26:29], v[120:127], v13
    s_mov_b64 exec, s[76:77]
    ds_write_b32 v59, v32 offset:512
    s_mov_b64 exec, 0xffff
    s_nop 2
    ds_write_b128 v45, v[48:51] offset:1024
    s_nop 0
    ds_write_b128 v45, v[52:55] offset:1040
    s_waitcnt lgkmcnt(0)
    s_barrier
    s_or_b32 s62, s69, s30
    s_cmp_lg_u32 s62, 0
    s_cbranch_scc1 EP_59
    v_mov_b32 v32, s31
    v_mov_b32 v33, 0
    s_mov_b32 exec_lo, 0x1
    s_mov_b32 exec_hi, 0x0
    buffer_store_dword v32, v33, s[36:39], 0 offen
EP_59:
    s_endpgm
HF_60:
    s_branch L_retF
L_fd:
    s_cmp_ge_u32 s30, 15
    s_cbranch_scc1 L_race
    s_mov_b32 s40, s20
    s_and_b32 s41, s21, 0xffff
    s_mov_b32 s42, 2211840
    s_mov_b32 s43, 0x20000
    v_lshlrev_b32 v60, 3, v3
    ds_write_b64 v60, v[48:49] offset:512
    ds_write_b32 v48, v48 offset:260
    s_sub_u32 s74, s30, 10
    v_mul_u32_u24 v11, 1280, v33
    v_lshl_add_u32 v11, v3, 4, v11
    s_mul_i32 s62, s69, 81920
    s_lshl_b32 s63, s74, 8
    s_add_u32 s62, s62, s63
    v_lshrrev_b32 v32, 3, v3
    v_mul_u32_u24 v58, 16512, v32
    v_bfe_u32 v32, v3, 2, 1
    v_mul_u32_u24 v32, 3456, v32
    v_add_u32 v58, v58, v32
    v_and_b32 v32, 3, v3
    v_lshl_add_u32 v58, v32, 4, v58
    v_lshl_add_u32 v58, v2, 13, v58
    s_lshl_b32 s72, s69, 7
    s_mul_i32 s73, s74, 33024
    s_add_u32 s72, s72, s73
    s_add_u32 s72, s72, 589824
    v_lshrrev_b32 v32, 1, v2
    v_mul_u32_u24 v59, 2048, v32
    v_lshl_add_u32 v59, v1, 4, v59
    s_waitcnt lgkmcnt(0)
    s_barrier
    buffer_load_dwordx4 v[64:67], v11, s[40:43], s62 offen offset:0 nt
    buffer_load_dwordx4 v[68:71], v11, s[40:43], s62 offen offset:2560 nt
    s_add_u32 s62, s62, 5120
    buffer_load_dwordx4 v[72:75], v11, s[40:43], s62 offen offset:0 nt
    buffer_load_dwordx4 v[76:79], v11, s[40:43], s62 offen offset:2560 nt
    s_add_u32 s62, s62, 15360
    buffer_load_dwordx4 v[80:83], v11, s[40:43], s62 offen offset:0 nt
    buffer_load_dwordx4 v[84:87], v11, s[40:43], s62 offen offset:2560 nt
    s_add_u32 s62, s62, 5120
    s_waitcnt vmcnt(5)
    buffer_load_dwordx4 v[88:91], v11, s[40:43], s62 offen offset:0 nt
    s_waitcnt vmcnt(5)
    buffer_load_dwordx4 v[92:95], v11, s[40:43], s62 offen offset:2560 nt
    s_add_u32 s62, s62, 15360
    s_waitcnt vmcnt(5)
    buffer_load_dwordx4 v[96:99], v11, s[40:43], s62 offen offset:0 nt
    s_waitcnt vmcnt(5)
    buffer_load_dwordx4 v[100:103], v11, s[40:43], s62 offen offset:2560 nt
    s_add_u32 s62, s62, 5120
    s_waitcnt vmcnt(5)
    buffer_load_dwordx4 v[104:107], v11, s[40:43], s62 offen offset:0 nt
    s_waitcnt vmcnt(5)
    buffer_load_dwordx4 v[108:111], v11, s[40:43], s62 offen offset:2560 nt
    s_add_u32 s62, s62, 15360
    s_waitcnt vmcnt(5)
    buffer_load_dwordx4 v[112:115], v11, s[40:43], s62 offen offset:0 nt
    s_waitcnt vmcnt(5)
    buffer_load_dwordx4 v[116:119], v11, s[40:43], s62 offen offset:2560 nt
    s_add_u32 s62, s62, 5120
    s_waitcnt vmcnt(5)
    buffer_load_dwordx4 v[120:123], v11, s[40:43], s62 offen offset:0 nt
    s_waitcnt vmcnt(5)
    buffer_load_dwordx4 v[124:127], v11, s[40:43], s62 offen offset:2560 nt
    s_waitcnt vmcnt(0)
    s_barrier
    ds_read_b128 v[14:17], v59 offset:10240
    ds_read_b128 v[18:21], v59 offset:10752
    ds_read_b128 v[22:25], v59 offset:11264
    ds_read_b128 v[26:29], v59 offset:11776
    ds_read_b128 v[30:33], v59 offset:12288
    s_waitcnt lgkmcnt(3)
    v_pk_add_f32 v[14:15], v[14:15], v[18:19]
    v_pk_add_f32 v[16:17], v[16:17], v[20:21]
    s_waitcnt lgkmcnt(1)
    v_pk_add_f32 v[22:23], v[22:23], v[26:27]
    v_pk_add_f32 v[24:25], v[24:25], v[28:29]
    s_waitcnt lgkmcnt(0)
    v_pk_add_f32 v[14:15], v[14:15], v[30:31]
    v_pk_add_f32 v[16:17], v[16:17], v[32:33]
    v_pk_add_f32 v[14:15], v[14:15], v[22:23]
    v_pk_add_f32 v[16:17], v[16:17], v[24:25]
    s_nop 1
    v_permlane32_swap_b32 v14, v16
    v_permlane32_swap_b32 v15, v17
    v_pk_add_f32 v[44:45], v[14:15], v[16:17]
    s_nop 1
    v_permlane16_swap_b32 v44, v45
    ds_read_b128 v[14:17], v59 offset:19456
    ds_read_b128 v[18:21], v59 offset:19968
    ds_read_b128 v[22:25], v59 offset:20480
    ds_read_b128 v[26:29], v59 offset:20992
    ds_read_b128 v[30:33], v59 offset:21504
    s_waitcnt lgkmcnt(3)
    v_pk_add_f32 v[14:15], v[14:15], v[18:19]
    v_pk_add_f32 v[16:17], v[16:17], v[20:21]
    s_waitcnt lgkmcnt(1)
    v_pk_add_f32 v[22:23], v[22:23], v[26:27]
    v_pk_add_f32 v[24:25], v[24:25], v[28:29]
    s_waitcnt lgkmcnt(0)
    v_pk_add_f32 v[14:15], v[14:15], v[30:31]
    v_pk_add_f32 v[16:17], v[16:17], v[32:33]
    v_pk_add_f32 v[14:15], v[14:15], v[22:23]
    v_pk_add_f32 v[16:17], v[16:17], v[24:25]
    s_nop 1
    v_permlane32_swap_b32 v14, v16
    v_permlane32_swap_b32 v15, v17
    v_pk_add_f32 v[46:47], v[14:15], v[16:17]
    s_nop 1
    v_permlane16_swap_b32 v46, v47
    s_waitcnt vmcnt(0)
    v_swap_b32 v66, v72
    v_swap_b32 v67, v73
    v_swap_b32 v70, v76
    v_swap_b32 v71, v77
    v_swap_b32 v82, v88
    v_swap_b32 v83, v89
    v_swap_b32 v86, v92
    v_swap_b32 v87, v93
    v_swap_b32 v98, v104
    v_swap_b32 v99, v105
    v_swap_b32 v102, v108
    v_swap_b32 v103, v109
    v_swap_b32 v114, v120
    v_swap_b32 v115, v121
    v_swap_b32 v118, v124
    v_swap_b32 v119, v125
    v_lshlrev_b32 v61, 2, v1
    v_mov_b32 v62, 1
    ds_write_b32 v61, v62 offset:768
    s_mov_b32 s34, 0
    s_cmp_ge_u32 s30, 14
    s_waitcnt lgkmcnt(0)
    s_branch HF_61x
HF_61:
    s_branch L_retF
HF_61x:
    s_barrier
    s_cbranch_scc0 L_lxn
L_lxs:
    ds_read_b32 v62, v61 offset:768
    s_add_u32 s34, s34, 1
    s_cmp_ge_u32 s34, 480000
    s_cbranch_scc1 L_lxd
    s_waitcnt lgkmcnt(0)
    v_cmp_eq_u32 vcc, 1, v62
    s_nop 0
    s_cbranch_vccnz L_lxs
    s_branch L_lxd
L_lxn:
    ds_read_b64 v[34:35], v60 offset:512
    ds_read_b128 v[14:17], v59 offset:1024
    ds_read_b128 v[18:21], v59 offset:1536
    ds_read_b128 v[22:25], v59 offset:2048
    ds_read_b128 v[26:29], v59 offset:2560
    ds_read_b128 v[30:33], v59 offset:3072
    s_waitcnt lgkmcnt(5)
    v_add_f32_dpp v34, v34, v34 quad_perm:[1,0,3,2] row_mask:0xf bank_mask:0xf
    v_add_f32_dpp v35, v35, v35 quad_perm:[1,0,3,2] row_mask:0xf bank_mask:0xf
    s_waitcnt lgkmcnt(3)
    v_pk_add_f32 v[14:15], v[14:15], v[18:19]
    v_pk_add_f32 v[16:17], v[16:17], v[20:21]
    v_add_f32_dpp v34, v34, v34 quad_perm:[2,3,0,1] row_mask:0xf bank_mask:0xf
    v_add_f32_dpp v35, v35, v35 quad_perm:[2,3,0,1] row_mask:0xf bank_mask:0xf
    s_waitcnt lgkmcnt(1)
    v_pk_add_f32 v[22:23], v[22:23], v[26:27]
    v_pk_add_f32 v[24:25], v[24:25], v[28:29]
    s_waitcnt lgkmcnt(0)
    v_pk_add_f32 v[14:15], v[14:15], v[30:31]
    v_pk_add_f32 v[16:17], v[16:17], v[32:33]
    v_pk_add_f32 v[14:15], v[14:15], v[22:23]
    v_pk_add_f32 v[16:17], v[16:17], v[24:25]
    v_add_f32_dpp v34, v34, v34 row_half_mirror row_mask:0xf bank_mask:0xf
    v_add_f32_dpp v35, v35, v35 row_half_mirror row_mask:0xf bank_mask:0xf
    v_permlane32_swap_b32 v14, v16
    v_permlane32_swap_b32 v15, v17
    v_add_f32_dpp v34, v34, v34 row_mirror row_mask:0xf bank_mask:0xf
    v_add_f32_dpp v35, v35, v35 row_mirror row_mask:0xf bank_mask:0xf
    v_pk_add_f32 v[40:41], v[14:15], v[16:17]
    v_mul_f32 v34, 0x3acccccd, v34
    v_mul_f32 v35, 0x3acccccd, v35
    v_permlane16_swap_b32 v40, v41
    v_fma_f32 v35, -v34, v34, v35
    v_add_f32 v34, s100, v34
    v_max_f32 v35, 0, v35
    v_cvt_pk_bf16_f32 v34, 0, v34
    v_cvt_pk_bf16_f32 v35, 0, v35
    v_add_f32 v35, 0x3727c5ac, v35
    v_sub_f32 v34, s100, v34
    v_cvt_pk_bf16_f32 v35, 0, v35
    v_sqrt_f32 v35, v35
    v_fmac_f32 v40, v34, v44
    v_cvt_pk_bf16_f32 v35, 0, v35
    v_rcp_f32 v36, v35
    v_fmac_f32 v41, v34, v45
    v_fma_f32 v40, v40, v36, v46
    v_cvt_pk_bf16_f32 v40, 0, v40
    v_mul_f32 v38, v40, v40
    v_mul_f32 v37, 0xc0135761, v40
    v_mul_f32 v38, 0x3d372713, v38
    v_fmac_f32 v37, v37, v38
    v_exp_f32 v37, v37
    v_fma_f32 v41, v41, v36, v47
    v_add_f32 v37, 1.0, v37
    v_rcp_f32 v37, v37
    v_cvt_pk_bf16_f32 v41, 0, v41
    v_mul_f32 v62, v40, v37
    v_cvt_pk_bf16_f32 v62, 0, v62
    v_mul_f32 v62, v62, v41
    v_cvt_pk_bf16_f32 v62, 0, v62
    ds_write_b32 v61, v62 offset:768
L_lxd:
    s_nop 0
    v_mov_b32_dpp v63, v62 quad_perm:[1,1,3,3] row_mask:0xf bank_mask:0xf
    v_mov_b32_dpp v14, v62 row_newbcast:0 row_mask:0xf bank_mask:0xf
    v_mov_b32_dpp v15, v62 row_newbcast:1 row_mask:0xf bank_mask:0xf
    v_mov_b64_dpp v[16:17], v[62:63] row_newbcast:2 row_mask:0xf bank_mask:0xf
    v_mov_b64_dpp v[18:19], v[62:63] row_newbcast:4 row_mask:0xf bank_mask:0xf
    s_nop 0
    v_smfmac_f32_16x16x64_bf16 v[48:51], v[14:17], v[64:71], v13
    v_mov_b64_dpp v[20:21], v[62:63] row_newbcast:6 row_mask:0xf bank_mask:0xf
    v_smfmac_f32_16x16x64_bf16 v[52:55], v[14:17], v[72:79], v13
    v_mov_b64_dpp v[22:23], v[62:63] row_newbcast:8 row_mask:0xf bank_mask:0xf
    v_smfmac_f32_16x16x64_bf16 v[48:51], v[18:21], v[80:87], v13
    v_mov_b64_dpp v[24:25], v[62:63] row_newbcast:10 row_mask:0xf bank_mask:0xf
    v_smfmac_f32_16x16x64_bf16 v[52:55], v[18:21], v[88:95], v13
    v_mov_b64_dpp v[26:27], v[62:63] row_newbcast:12 row_mask:0xf bank_mask:0xf
    v_smfmac_f32_16x16x64_bf16 v[48:51], v[22:25], v[96:103], v13
    v_mov_b64_dpp v[28:29], v[62:63] row_newbcast:14 row_mask:0xf bank_mask:0xf
    v_smfmac_f32_16x16x64_bf16 v[52:55], v[22:25], v[104:111], v13
    s_nop 0
    v_smfmac_f32_16x16x64_bf16 v[48:51], v[26:29], v[112:119], v13
    v_smfmac_f32_16x16x64_bf16 v[52:55], v[26:29], v[120:127], v13
    s_mov_b32 exec_hi, 0
    s_nop 5
    v_bfi_b32 v48, s35, v9, v48
    buffer_store_dwordx4 v[48:51], v58, s[36:39], s72 offen offset:0 sc1
    v_bfi_b32 v52, s35, v9, v52
    buffer_store_dwordx4 v[52:55], v58, s[36:39], s72 offen offset:64 sc1
    s_endpgm
.section .rodata,"a"
.p2align 6
.amdhsa_kernel adaLN_cond__sliding_block_cached__geglu_ffn__decode_kernel
  .amdhsa_next_free_vgpr 128
  .amdhsa_next_free_sgpr 102
  .amdhsa_accum_offset 128
  .amdhsa_group_segment_fixed_size 0
  .amdhsa_kernarg_size 112
  .amdhsa_user_sgpr_count 2
  .amdhsa_user_sgpr_kernarg_segment_ptr 1
  .amdhsa_system_sgpr_workgroup_id_x 1
  .amdhsa_float_denorm_mode_32 3
.end_amdhsa_kernel
```
